```python
import torch

def _softmax(x, axis=-1):
    return torch.softmax(x, dim=axis)
def _gelu(x):
    return torch.nn.functional.gelu(x, approximate="tanh")
def _silu(x):
    return torch.nn.functional.silu(x)
def _sigmoid(x):
    return torch.sigmoid(x)
def _layernorm(x, axis=-1, eps=1e-5):
    m = x.mean(dim=axis, keepdim=True)
    v = x.var(dim=axis, keepdim=True, unbiased=False)
    return (x - m) / torch.sqrt(v + eps)
def _scatter_add(tgt, idx, src, axis=0):
    return tgt.clone().index_add_(axis, idx, src)
def _segment_sum(src, seg, n):
    out = torch.zeros((n,) + src.shape[1:], dtype=src.dtype)
    return out.index_add_(0, seg, src)
def _pad(x, pw):
    flat = tuple(v for pair in reversed(pw) for v in pair)
    return torch.nn.functional.pad(x, flat)

kernel_name = 'standalone__modern_conv_block_slak__vision'

def setup_inputs():

    _w = (lambda a: (lambda t: t.to(torch.bfloat16) if t.is_floating_point() else t)(torch.as_tensor(a)))
    H = W = 224
    C = 96
    K = 7
    return {
        "x": _w((lambda *s: torch.randn(*s, dtype=torch.bfloat16) * 0.05)(1, H, W, C)),
        "dw": _w((lambda *s: torch.randn(*s, dtype=torch.bfloat16) * 0.05)(K, K, C)),
        "w1": _w((lambda *s: torch.randn(*s, dtype=torch.bfloat16) * 0.05)(C, 4 * C)),
        "w2": _w((lambda *s: torch.randn(*s, dtype=torch.bfloat16) * 0.05)(4 * C, C)),
        "grn_g": _w((lambda *s: torch.randn(*s, dtype=torch.bfloat16) * 0.05)(4 * C)),
        "grn_b": _w((lambda *s: torch.randn(*s, dtype=torch.bfloat16) * 0.05)(4 * C)),
    }

def reference(x, dw, w1, w2, grn_g, grn_b):
    B, H, W, C = x.shape
    K = dw.shape[0]
    pad = K // 2
    xp = _pad(x, ((0,0),(pad,pad),(pad,pad),(0,0)))
    out = torch.zeros_like(x)
    for i in range(K):
        for j in range(K):
            out = out + xp[:, i:i+H, j:j+W, :] * dw[i, j][None, None, None, :]
    h = _layernorm(out, axis=-1)
    h = _gelu(h @ w1)
    gx = torch.sqrt((h * h).sum(axis=(1, 2), keepdims=True) + 1e-6)
    nx = gx / (gx.mean(axis=-1, keepdims=True) + 1e-6)
    h = grn_g[None, None, None, :] * (h * nx) + grn_b[None, None, None, :] + h
    return x + h @ w2
```

```asm
; @launch grid=(256,1,1) block=(512,1,1) lds=163840
.amdgcn_target "amdgcn-amd-amdhsa--gfx950"
.text
.p2align 13
.globl standalone__modern_conv_block_slak__vision_kernel
.p2align 8
.type standalone__modern_conv_block_slak__vision_kernel,@function
standalone__modern_conv_block_slak__vision_kernel:
    s_load_dwordx16 s[4:19], s[0:1], 0
    s_load_dwordx2 s[20:21], s[0:1], 64
    s_cmp_ge_u32 s2, 256
    s_cbranch_scc1 L_end
    v_lshrrev_b32 v1, 6, v0
    v_and_b32 v2, 63, v0
    v_readfirstlane_b32 s60, v1
    v_mov_b32 v14, 162816
    s_getpc_b64 s[36:37]
    s_and_b32 s36, s36, 0xffffff00
    s_cmp_lg_u32 s60, 5
    s_cbranch_scc1 L_sk1
    v_mov_b32 v8, 0
    v_mov_b32 v9, 0
    v_mov_b32 v10, 0
    v_mov_b32_e64 v11, 0
    ds_write_b128 v14, v[8:11]
    ds_write_b128 v14, v[8:11] offset:16
L_sk1:
    v_lshlrev_b32 v15, 4, v2
    s_lshr_b32 s71, s2, 3
    s_cmp_lg_u32 s60, 6
    s_cbranch_scc1 L_sk2
    s_mov_b32 s38, L_end-standalone__modern_conv_block_slak__vision_kernel
    s_mov_b32 s39, 0x00020000
    s_and_b32 s70, s71, 7
    s_lshl_b32 s70, s70, 12
    buffer_load_dwordx4 v[48:51], v15, s[36:39], s70 offen offset:0
    buffer_load_dwordx4 v[52:55], v15, s[36:39], s70 offen offset:1024
    buffer_load_dwordx4 v[56:59], v15, s[36:39], s70 offen offset:2048
    buffer_load_dwordx4 v[60:63], v15, s[36:39], s70 offen offset:3072
L_sk2:
    s_and_b32 s70, s2, 7
    s_lshr_b32 s61, s70, 1
    s_lshl_b32 s61, s61, 2
    s_lshr_b32 s72, s71, 3
    s_add_u32 s61, s61, s72
    s_and_b32 s62, s70, 1
    s_lshl_b32 s62, s62, 3
    s_and_b32 s72, s71, 7
    s_add_u32 s62, s62, s72
    s_lshl_b32 s81, s70, 5
    s_add_u32 s81, s81, s71
    s_mul_i32 s61, s61, 14
    s_mul_i32 s62, s62, 14
    v_mul_u32_u24 v4, 43, v2
    v_lshrrev_b32 v4, 9, v4
    v_mul_u32_u24 v5, 12, v4
    v_sub_u32 v5, v2, v5
    s_sub_u32 s70, s62, 3
    v_lshl_add_u32 v6, v4, 2, s70
    s_movk_i32 s67, 192
    v_lshlrev_b32 v7, 4, v5
    v_mad_i32_i24 v7, v6, s67, v7
    v_sub_u32 v12, 223, v6
    v_and_b32 v12, 0x80000000, v12
    v_add_u32_e64 v8, v7, v12
    v_sub_u32 v12, 222, v6
    v_and_b32 v12, 0x80000000, v12
    v_add_u32 v12, 192, v12
    v_add_u32_e64 v9, v7, v12
    v_sub_u32 v12, 221, v6
    v_and_b32 v12, 0x80000000, v12
    v_add_u32 v12, 384, v12
    v_add_u32_e64 v10, v7, v12
    v_sub_u32 v12, 220, v6
    v_and_b32 v12, 0x80000000, v12
    v_add_u32 v12, 576, v12
    v_add_u32_e64 v11, v7, v12
    s_cmp_lt_u32 s60, 4
    s_cselect_b32 s82, 8, 1
    s_cselect_b32 s72, 4, -5
    s_cselect_b32 s70, 8, -2
    s_mul_i32 s72, s72, 43008
    s_mul_i32 s70, s70, 43008
    s_add_u32 s82, s82, s60
    s_add_u32 s73, s61, s82
    s_sub_u32 s73, s73, 3
    s_mul_i32 s73, s73, 43008
    s_add_u32 s72, s72, s73
    s_add_u32 s70, s70, s73
    s_mov_b32 s26, 9633792
    s_mov_b32 s27, 0x00020000
    s_mov_b32 s30, 9408
    s_mov_b32 s31, 0x00020000
    s_waitcnt lgkmcnt(0)
    s_cmp_lg_u32 s60, 7
    s_cbranch_scc1 L_sk3
    s_mov_b64 s[28:29], s[6:7]
    s_mov_b32 m0, 151808
    s_mov_b32 s72, 4096
    s_mov_b32 s73, 8192
    buffer_load_dwordx4 v15, s[28:31], 0 offen offset:0 lds
    buffer_load_dwordx4 v15, s[28:31], 0 offen offset:1024 lds
    buffer_load_dwordx4 v15, s[28:31], 0 offen offset:2048 lds
    buffer_load_dwordx4 v15, s[28:31], 0 offen offset:3072 lds
    s_mov_b32 m0, 155904
    s_nop 0
    buffer_load_dwordx4 v15, s[28:31], s72 offen offset:0 lds
    buffer_load_dwordx4 v15, s[28:31], s72 offen offset:1024 lds
    buffer_load_dwordx4 v15, s[28:31], s72 offen offset:2048 lds
    buffer_load_dwordx4 v15, s[28:31], s72 offen offset:3072 lds
    s_mov_b32 m0, 160000
    s_nop 0
    buffer_load_dwordx4 v15, s[28:31], s73 offen offset:0 lds
    buffer_load_dwordx4 v15, s[28:31], s73 offen offset:1024 lds
    s_mov_b64 s[32:33], s[8:9]
    s_mov_b32 s34, 73728
    s_mov_b32 s35, 0x00020000
    s_mul_i32 s72, s71, 2304
    s_mov_b32 m0, 0
    s_nop 0
    buffer_load_dwordx4 v15, s[32:35], s72 offen offset:0 lds
    buffer_load_dwordx4 v15, s[32:35], s72 offen offset:1024 lds
    buffer_load_dwordx4 v15, s[32:35], s72 offen offset:1280 lds
L_sk3:
    s_barrier
    s_mov_b64 s[24:25], s[4:5]
    s_cmp_ge_u32 s60, 7
    s_cbranch_scc1 L_sk4
    s_mov_b32 exec_hi, 0x0fffffff
    buffer_load_dwordx4 v[16:19], v8, s[24:27], s73 offen
    buffer_load_dwordx4 v[20:23], v9, s[24:27], s73 offen
    buffer_load_dwordx4 v[24:27], v10, s[24:27], s73 offen
    buffer_load_dwordx4 v[28:31], v11, s[24:27], s73 offen
    s_mov_b32 exec_hi, -1
L_sk4:
    s_and_b32 s63, s60, 3
    s_lshr_b32 s64, s60, 2
    s_mov_b32 s65, 0x05040100
    s_mov_b32 s66, 0x07060302
    v_lshrrev_b32 v12, 1, v4
    v_and_b32_e64 v13, 1, v4
    v_mul_u32_u24 v1, 1296, v5
    s_lshl_b32 s73, s82, 4
    s_add_u32 s73, s73, 73728
    v_add_u32_e64 v1, s73, v1
    s_cmp_lt_u32 s60, 4
    s_cselect_b32 s82, 64, -80
    s_cselect_b32 s83, 64, 48
    v_mul_u32_u24 v12, 15616, v12
    v_lshl_add_u32 v12, v13, 3, v12
    v_add_u32 v6, v1, v12
    v_sub_u32_e64 v7, v1, v12
    v_add_u32 v7, 62472, v7
    s_mov_b64 s[32:33], s[8:9]
    s_mov_b32 s34, 73728
    s_mov_b32 s35, 0x00020000
    s_mov_b64 s[36:37], s[10:11]
    s_mov_b32 s38, 73728
    s_mov_b32 s39, 0x00020000
    s_mov_b64 s[44:45], s[20:21]
    s_mov_b32 s46, 1179648
    s_mov_b32 s47, 0x00020000
    s_cmp_ge_u32 s60, 4
    s_cbranch_scc1 L_sk5
    s_mov_b32 exec_hi, 0x0fffffff
    buffer_load_dwordx4 v[32:35], v8, s[24:27], s72 offen
    buffer_load_dwordx4 v[36:39], v9, s[24:27], s72 offen
    buffer_load_dwordx4 v[40:43], v10, s[24:27], s72 offen
    buffer_load_dwordx4 v[44:47], v11, s[24:27], s72 offen
    s_mov_b32 exec_hi, -1
L_sk5:
    v_lshrrev_b32 v12, 4, v2
    v_and_b32 v13, 1, v2
    v_sub_u32_e64 v12, v12, v13
    v_bfe_u32 v13, v2, 1, 3
    v_mul_i32_i24 v12, 7, v12
    v_sub_u32_e64 v12, v12, v13
    s_mul_i32 s73, s60, 24
    s_add_u32 s73, s73, 1152
    v_add_u32 v1, 1, v13
    v_and_b32 v1, 8, v1
    v_lshl_add_u32 v1, v1, 20, s73
    v_mad_i32_i24 v4, v12, s67, v1
    v_add_u32 v5, 5376, v4
    v_min_u32 v4, 9408, v4
    v_min_u32 v5, 9408, v5
    v_add_u32 v4, 151808, v4
    v_add_u32 v5, 151808, v5
    s_getreg_b32 s80, hwreg(HW_REG_XCC_ID)
    s_and_b32 s80, s80, 7
    s_mov_b64 s[48:49], s[18:19]
    s_mov_b32 s50, 256
    s_mov_b32 s51, 0x00020000
    s_mov_b64 s[40:41], s[16:17]
    s_mov_b32 s42, 9633792
    s_mov_b32 s43, 0x00020000
    s_mov_b64 s[52:53], s[12:13]
    s_mov_b32 s54, 768
    s_mov_b32 s55, 0x00020000
    s_mov_b64 s[56:57], s[14:15]
    s_mov_b32 s58, 768
    s_mov_b32 s59, 0x00020000
    s_mov_b32 s68, 0x409d30fc
    s_mov_b32 s69, 0x409d30fc
    s_cmp_ge_u32 s60, 4
    s_cbranch_scc1 L_sk6
    s_mov_b32 exec_hi, 0x0fffffff
    buffer_load_dwordx4 v[48:51], v8, s[24:27], s70 offen
    buffer_load_dwordx4 v[52:55], v9, s[24:27], s70 offen
    buffer_load_dwordx4 v[56:59], v10, s[24:27], s70 offen
    buffer_load_dwordx4 v[60:63], v11, s[24:27], s70 offen
    s_mov_b32 exec_hi, -1
L_sk6:
    s_cmp_lg_u32 s60, 7
    s_cbranch_scc1 L_sk7
    v_mov_b32_e64 v13, 1
    s_waitcnt vmcnt(0)
    ds_write_b32 v14, v13
L_sk7:
L_dwpoll:
    ds_read_b32 v13, v14
    s_waitcnt lgkmcnt(0)
    v_readfirstlane_b32 s78, v13
    s_nop 1
    s_cmp_eq_u32 s78, 1
    s_cbranch_scc1 L_dwok
    s_sleep 1
    s_branch L_dwpoll
L_dwok:
    ds_read_b64 v[100:101], v4 offset:0
    ds_read_b64 v[102:103], v4 offset:8
    ds_read_b64 v[104:105], v4 offset:16
    ds_read_b64 v[108:109], v5 offset:0
    ds_read_b64 v[110:111], v5 offset:8
    ds_read_b64 v[96:97], v5 offset:16
    s_waitcnt lgkmcnt(5)
    v_mov_b32_dpp v132, v100 row_shr:2 row_mask:0xf bank_mask:0xf bound_ctrl:0
    v_mov_b32_dpp v133, v101 row_shr:2 row_mask:0xf bank_mask:0xf bound_ctrl:0
    s_waitcnt lgkmcnt(4)
    v_mov_b32_dpp v134, v102 row_shr:2 row_mask:0xf bank_mask:0xf bound_ctrl:0
    v_mov_b32_dpp v135, v103 row_shr:2 row_mask:0xf bank_mask:0xf bound_ctrl:0
    s_waitcnt lgkmcnt(3)
    v_mov_b32_dpp v136, v104 row_shr:2 row_mask:0xf bank_mask:0xf bound_ctrl:0
    v_mov_b32_dpp v137, v105 row_shr:2 row_mask:0xf bank_mask:0xf bound_ctrl:0
    s_waitcnt lgkmcnt(2)
    v_mov_b32_dpp v140, v108 row_shr:2 row_mask:0xf bank_mask:0xf bound_ctrl:0
    v_mov_b32_dpp v141, v109 row_shr:2 row_mask:0xf bank_mask:0xf bound_ctrl:0
    s_waitcnt lgkmcnt(1)
    v_mov_b32_dpp v142, v110 row_shr:2 row_mask:0xf bank_mask:0xf bound_ctrl:0
    v_mov_b32_dpp v143, v111 row_shr:2 row_mask:0xf bank_mask:0xf bound_ctrl:0
    s_waitcnt lgkmcnt(0)
    v_mov_b32_dpp v128, v96 row_shr:2 row_mask:0xf bank_mask:0xf bound_ctrl:0
    v_mov_b32_dpp v129, v97 row_shr:2 row_mask:0xf bank_mask:0xf bound_ctrl:0
    v_perm_b32 v67, v132, v100, s65
    v_perm_b32 v75, v140, v108, s65
    v_perm_b32 v81, v132, v100, s66
    v_perm_b32 v89, v140, v108, s66
    v_perm_b32 v99, v133, v101, s65
    v_perm_b32 v107, v141, v109, s65
    v_perm_b32 v113, v133, v101, s66
    v_perm_b32 v121, v141, v109, s66
    v_perm_b32 v131, v134, v102, s65
    v_perm_b32 v139, v142, v110, s65
    v_perm_b32 v145, v134, v102, s66
    v_perm_b32 v153, v142, v110, s66
    v_perm_b32 v163, v135, v103, s65
    v_perm_b32 v171, v143, v111, s65
    v_perm_b32 v177, v135, v103, s66
    v_perm_b32 v185, v143, v111, s66
    v_perm_b32 v195, v136, v104, s65
    v_perm_b32 v203, v128, v96, s65
    v_perm_b32 v209, v136, v104, s66
    v_perm_b32 v217, v128, v96, s66
    v_perm_b32 v227, v137, v105, s65
    v_perm_b32 v235, v129, v97, s65
    v_perm_b32 v241, v137, v105, s66
    v_perm_b32 v249, v129, v97, s66
    v_mov_b32_dpp v64, v67 row_shl:12 row_mask:0xf bank_mask:0xf bound_ctrl:0
    v_mov_b32_dpp v65, v67 row_shl:8 row_mask:0xf bank_mask:0xf bound_ctrl:0
    v_mov_b32_dpp v66, v67 row_shl:4 row_mask:0xf bank_mask:0xf bound_ctrl:0
    v_mov_b32_dpp v68, v67 row_shr:4 row_mask:0xf bank_mask:0xf bound_ctrl:0
    v_mov_b32_dpp v69, v67 row_shr:8 row_mask:0xf bank_mask:0xf bound_ctrl:0
    v_mov_b32_dpp v70, v67 row_shr:12 row_mask:0xf bank_mask:0xf bound_ctrl:0
    v_mov_b32 v71, 0
    v_mov_b32_dpp v72, v75 row_shl:12 row_mask:0xf bank_mask:0xf bound_ctrl:0
    v_mov_b32_dpp v73, v75 row_shl:8 row_mask:0xf bank_mask:0xf bound_ctrl:0
    v_mov_b32_dpp v74, v75 row_shl:4 row_mask:0xf bank_mask:0xf bound_ctrl:0
    v_mov_b32_dpp v76, v75 row_shr:4 row_mask:0xf bank_mask:0xf bound_ctrl:0
    v_mov_b32_dpp v77, v75 row_shr:8 row_mask:0xf bank_mask:0xf bound_ctrl:0
    v_mov_b32_dpp v78, v75 row_shr:12 row_mask:0xf bank_mask:0xf bound_ctrl:0
    v_mov_b32_e64 v79, 0
    v_mov_b32_dpp v82, v81 row_shl:12 row_mask:0xf bank_mask:0xf bound_ctrl:0
    v_mov_b32_dpp v83, v81 row_shl:8 row_mask:0xf bank_mask:0xf bound_ctrl:0
    v_mov_b32_dpp v80, v81 row_shl:4 row_mask:0xf bank_mask:0xf bound_ctrl:0
    v_mov_b32_dpp v86, v81 row_shr:4 row_mask:0xf bank_mask:0xf bound_ctrl:0
    v_mov_b32_dpp v87, v81 row_shr:8 row_mask:0xf bank_mask:0xf bound_ctrl:0
    v_mov_b32_dpp v84, v81 row_shr:12 row_mask:0xf bank_mask:0xf bound_ctrl:0
    v_mov_b32_e64 v85, 0
    v_mov_b32_dpp v90, v89 row_shl:12 row_mask:0xf bank_mask:0xf bound_ctrl:0
    v_mov_b32_dpp v91, v89 row_shl:8 row_mask:0xf bank_mask:0xf bound_ctrl:0
    v_mov_b32_dpp v88, v89 row_shl:4 row_mask:0xf bank_mask:0xf bound_ctrl:0
    v_mov_b32_dpp v94, v89 row_shr:4 row_mask:0xf bank_mask:0xf bound_ctrl:0
    v_mov_b32_dpp v95, v89 row_shr:8 row_mask:0xf bank_mask:0xf bound_ctrl:0
    v_mov_b32_dpp v92, v89 row_shr:12 row_mask:0xf bank_mask:0xf bound_ctrl:0
    v_mov_b32_e64 v93, 0
    v_mov_b32_dpp v96, v99 row_shl:12 row_mask:0xf bank_mask:0xf bound_ctrl:0
    v_mov_b32_dpp v97, v99 row_shl:8 row_mask:0xf bank_mask:0xf bound_ctrl:0
    v_mov_b32_dpp v98, v99 row_shl:4 row_mask:0xf bank_mask:0xf bound_ctrl:0
    v_mov_b32_dpp v100, v99 row_shr:4 row_mask:0xf bank_mask:0xf bound_ctrl:0
    v_mov_b32_dpp v101, v99 row_shr:8 row_mask:0xf bank_mask:0xf bound_ctrl:0
    v_mov_b32_dpp v102, v99 row_shr:12 row_mask:0xf bank_mask:0xf bound_ctrl:0
    v_mov_b32_e64 v103, 0
    v_mov_b32_dpp v104, v107 row_shl:12 row_mask:0xf bank_mask:0xf bound_ctrl:0
    v_mov_b32_dpp v105, v107 row_shl:8 row_mask:0xf bank_mask:0xf bound_ctrl:0
    v_mov_b32_dpp v106, v107 row_shl:4 row_mask:0xf bank_mask:0xf bound_ctrl:0
    v_mov_b32_dpp v108, v107 row_shr:4 row_mask:0xf bank_mask:0xf bound_ctrl:0
    v_mov_b32_dpp v109, v107 row_shr:8 row_mask:0xf bank_mask:0xf bound_ctrl:0
    v_mov_b32_dpp v110, v107 row_shr:12 row_mask:0xf bank_mask:0xf bound_ctrl:0
    v_mov_b32_e64 v111, 0
    v_mov_b32_dpp v114, v113 row_shl:12 row_mask:0xf bank_mask:0xf bound_ctrl:0
    v_mov_b32_dpp v115, v113 row_shl:8 row_mask:0xf bank_mask:0xf bound_ctrl:0
    v_mov_b32_dpp v112, v113 row_shl:4 row_mask:0xf bank_mask:0xf bound_ctrl:0
    v_mov_b32_dpp v118, v113 row_shr:4 row_mask:0xf bank_mask:0xf bound_ctrl:0
    v_mov_b32_dpp v119, v113 row_shr:8 row_mask:0xf bank_mask:0xf bound_ctrl:0
    v_mov_b32_dpp v116, v113 row_shr:12 row_mask:0xf bank_mask:0xf bound_ctrl:0
    v_mov_b32_e64 v117, 0
    v_mov_b32_dpp v122, v121 row_shl:12 row_mask:0xf bank_mask:0xf bound_ctrl:0
    v_mov_b32_dpp v123, v121 row_shl:8 row_mask:0xf bank_mask:0xf bound_ctrl:0
    v_mov_b32_dpp v120, v121 row_shl:4 row_mask:0xf bank_mask:0xf bound_ctrl:0
    v_mov_b32_dpp v126, v121 row_shr:4 row_mask:0xf bank_mask:0xf bound_ctrl:0
    v_mov_b32_dpp v127, v121 row_shr:8 row_mask:0xf bank_mask:0xf bound_ctrl:0
    v_mov_b32_dpp v124, v121 row_shr:12 row_mask:0xf bank_mask:0xf bound_ctrl:0
    v_mov_b32_e64 v125, 0
    s_cmp_lt_u32 s60, 4
    s_cbranch_scc1 L_sk8
    s_cmp_ge_u32 s60, 7
    s_cbranch_scc1 L_sk9
    s_mov_b32 exec_hi, 0x0fffffff
    buffer_load_dwordx4 v[32:35], v8, s[24:27], s72 offen
    buffer_load_dwordx4 v[36:39], v9, s[24:27], s72 offen
    buffer_load_dwordx4 v[40:43], v10, s[24:27], s72 offen
    buffer_load_dwordx4 v[44:47], v11, s[24:27], s72 offen
    s_mov_b32 exec_hi, -1
L_sk9:
L_sk8:
    v_mov_b32_dpp v128, v131 row_shl:12 row_mask:0xf bank_mask:0xf bound_ctrl:0
    v_mov_b32_dpp v129, v131 row_shl:8 row_mask:0xf bank_mask:0xf bound_ctrl:0
    v_mov_b32_dpp v130, v131 row_shl:4 row_mask:0xf bank_mask:0xf bound_ctrl:0
    v_mov_b32_dpp v132, v131 row_shr:4 row_mask:0xf bank_mask:0xf bound_ctrl:0
    v_mov_b32_dpp v133, v131 row_shr:8 row_mask:0xf bank_mask:0xf bound_ctrl:0
    v_mov_b32_dpp v134, v131 row_shr:12 row_mask:0xf bank_mask:0xf bound_ctrl:0
    v_mov_b32 v135, 0
    v_mov_b32_dpp v136, v139 row_shl:12 row_mask:0xf bank_mask:0xf bound_ctrl:0
    v_mov_b32_dpp v137, v139 row_shl:8 row_mask:0xf bank_mask:0xf bound_ctrl:0
    v_mov_b32_dpp v138, v139 row_shl:4 row_mask:0xf bank_mask:0xf bound_ctrl:0
    v_mov_b32_dpp v140, v139 row_shr:4 row_mask:0xf bank_mask:0xf bound_ctrl:0
    v_mov_b32_dpp v141, v139 row_shr:8 row_mask:0xf bank_mask:0xf bound_ctrl:0
    v_mov_b32_dpp v142, v139 row_shr:12 row_mask:0xf bank_mask:0xf bound_ctrl:0
    v_mov_b32_e64 v143, 0
    v_mov_b32_dpp v146, v145 row_shl:12 row_mask:0xf bank_mask:0xf bound_ctrl:0
    v_mov_b32_dpp v147, v145 row_shl:8 row_mask:0xf bank_mask:0xf bound_ctrl:0
    v_mov_b32_dpp v144, v145 row_shl:4 row_mask:0xf bank_mask:0xf bound_ctrl:0
    v_mov_b32_dpp v150, v145 row_shr:4 row_mask:0xf bank_mask:0xf bound_ctrl:0
    v_mov_b32_dpp v151, v145 row_shr:8 row_mask:0xf bank_mask:0xf bound_ctrl:0
    v_mov_b32_dpp v148, v145 row_shr:12 row_mask:0xf bank_mask:0xf bound_ctrl:0
    v_mov_b32_e64 v149, 0
    v_mov_b32_dpp v154, v153 row_shl:12 row_mask:0xf bank_mask:0xf bound_ctrl:0
    v_mov_b32_dpp v155, v153 row_shl:8 row_mask:0xf bank_mask:0xf bound_ctrl:0
    v_mov_b32_dpp v152, v153 row_shl:4 row_mask:0xf bank_mask:0xf bound_ctrl:0
    v_mov_b32_dpp v158, v153 row_shr:4 row_mask:0xf bank_mask:0xf bound_ctrl:0
    v_mov_b32_dpp v159, v153 row_shr:8 row_mask:0xf bank_mask:0xf bound_ctrl:0
    v_mov_b32_dpp v156, v153 row_shr:12 row_mask:0xf bank_mask:0xf bound_ctrl:0
    v_mov_b32_e64 v157, 0
    v_mov_b32_dpp v160, v163 row_shl:12 row_mask:0xf bank_mask:0xf bound_ctrl:0
    v_mov_b32_dpp v161, v163 row_shl:8 row_mask:0xf bank_mask:0xf bound_ctrl:0
    v_mov_b32_dpp v162, v163 row_shl:4 row_mask:0xf bank_mask:0xf bound_ctrl:0
    v_mov_b32_dpp v164, v163 row_shr:4 row_mask:0xf bank_mask:0xf bound_ctrl:0
    v_mov_b32_dpp v165, v163 row_shr:8 row_mask:0xf bank_mask:0xf bound_ctrl:0
    v_mov_b32_dpp v166, v163 row_shr:12 row_mask:0xf bank_mask:0xf bound_ctrl:0
    v_mov_b32_e64 v167, 0
    v_mov_b32_dpp v168, v171 row_shl:12 row_mask:0xf bank_mask:0xf bound_ctrl:0
    v_mov_b32_dpp v169, v171 row_shl:8 row_mask:0xf bank_mask:0xf bound_ctrl:0
    v_mov_b32_dpp v170, v171 row_shl:4 row_mask:0xf bank_mask:0xf bound_ctrl:0
    v_mov_b32_dpp v172, v171 row_shr:4 row_mask:0xf bank_mask:0xf bound_ctrl:0
    v_mov_b32_dpp v173, v171 row_shr:8 row_mask:0xf bank_mask:0xf bound_ctrl:0
    v_mov_b32_dpp v174, v171 row_shr:12 row_mask:0xf bank_mask:0xf bound_ctrl:0
    v_mov_b32_e64 v175, 0
    v_mov_b32_dpp v178, v177 row_shl:12 row_mask:0xf bank_mask:0xf bound_ctrl:0
    v_mov_b32_dpp v179, v177 row_shl:8 row_mask:0xf bank_mask:0xf bound_ctrl:0
    v_mov_b32_dpp v176, v177 row_shl:4 row_mask:0xf bank_mask:0xf bound_ctrl:0
    v_mov_b32_dpp v182, v177 row_shr:4 row_mask:0xf bank_mask:0xf bound_ctrl:0
    v_mov_b32_dpp v183, v177 row_shr:8 row_mask:0xf bank_mask:0xf bound_ctrl:0
    v_mov_b32_dpp v180, v177 row_shr:12 row_mask:0xf bank_mask:0xf bound_ctrl:0
    v_mov_b32_e64 v181, 0
    v_mov_b32_dpp v186, v185 row_shl:12 row_mask:0xf bank_mask:0xf bound_ctrl:0
    v_mov_b32_dpp v187, v185 row_shl:8 row_mask:0xf bank_mask:0xf bound_ctrl:0
    v_mov_b32_dpp v184, v185 row_shl:4 row_mask:0xf bank_mask:0xf bound_ctrl:0
    v_mov_b32_dpp v190, v185 row_shr:4 row_mask:0xf bank_mask:0xf bound_ctrl:0
    v_mov_b32_dpp v191, v185 row_shr:8 row_mask:0xf bank_mask:0xf bound_ctrl:0
    v_mov_b32_dpp v188, v185 row_shr:12 row_mask:0xf bank_mask:0xf bound_ctrl:0
    v_mov_b32_e64 v189, 0
    s_cmp_lt_u32 s60, 4
    s_cbranch_scc1 L_sk10
    s_cmp_ge_u32 s60, 6
    s_cbranch_scc1 L_sk11
    s_mov_b32 exec_hi, 0x0fffffff
    buffer_load_dwordx4 v[48:51], v8, s[24:27], s70 offen
    buffer_load_dwordx4 v[52:55], v9, s[24:27], s70 offen
    buffer_load_dwordx4 v[56:59], v10, s[24:27], s70 offen
    buffer_load_dwordx4 v[60:63], v11, s[24:27], s70 offen
    s_mov_b32 exec_hi, -1
L_sk11:
L_sk10:
    v_mov_b32_e64 v13, 1
    s_mov_b64 exec, 1
    ds_add_u32 v14, v13 offset:16
    s_mov_b64 exec, -1
    v_mov_b32_dpp v192, v195 row_shl:12 row_mask:0xf bank_mask:0xf bound_ctrl:0
    v_mov_b32_dpp v193, v195 row_shl:8 row_mask:0xf bank_mask:0xf bound_ctrl:0
    v_mov_b32_dpp v194, v195 row_shl:4 row_mask:0xf bank_mask:0xf bound_ctrl:0
    v_mov_b32_dpp v196, v195 row_shr:4 row_mask:0xf bank_mask:0xf bound_ctrl:0
    v_mov_b32_dpp v197, v195 row_shr:8 row_mask:0xf bank_mask:0xf bound_ctrl:0
    v_mov_b32_dpp v198, v195 row_shr:12 row_mask:0xf bank_mask:0xf bound_ctrl:0
    v_mov_b32 v199, 0
    v_mov_b32_dpp v200, v203 row_shl:12 row_mask:0xf bank_mask:0xf bound_ctrl:0
    v_mov_b32_dpp v201, v203 row_shl:8 row_mask:0xf bank_mask:0xf bound_ctrl:0
    v_mov_b32_dpp v202, v203 row_shl:4 row_mask:0xf bank_mask:0xf bound_ctrl:0
    v_mov_b32_dpp v204, v203 row_shr:4 row_mask:0xf bank_mask:0xf bound_ctrl:0
    v_mov_b32_dpp v205, v203 row_shr:8 row_mask:0xf bank_mask:0xf bound_ctrl:0
    v_mov_b32_dpp v206, v203 row_shr:12 row_mask:0xf bank_mask:0xf bound_ctrl:0
    v_mov_b32_e64 v207, 0
    v_mov_b32_dpp v210, v209 row_shl:12 row_mask:0xf bank_mask:0xf bound_ctrl:0
    v_mov_b32_dpp v211, v209 row_shl:8 row_mask:0xf bank_mask:0xf bound_ctrl:0
    v_mov_b32_dpp v208, v209 row_shl:4 row_mask:0xf bank_mask:0xf bound_ctrl:0
    v_mov_b32_dpp v214, v209 row_shr:4 row_mask:0xf bank_mask:0xf bound_ctrl:0
    v_mov_b32_dpp v215, v209 row_shr:8 row_mask:0xf bank_mask:0xf bound_ctrl:0
    v_mov_b32_dpp v212, v209 row_shr:12 row_mask:0xf bank_mask:0xf bound_ctrl:0
    v_mov_b32_e64 v213, 0
    v_mov_b32_dpp v218, v217 row_shl:12 row_mask:0xf bank_mask:0xf bound_ctrl:0
    v_mov_b32_dpp v219, v217 row_shl:8 row_mask:0xf bank_mask:0xf bound_ctrl:0
    v_mov_b32_dpp v216, v217 row_shl:4 row_mask:0xf bank_mask:0xf bound_ctrl:0
    v_mov_b32_dpp v222, v217 row_shr:4 row_mask:0xf bank_mask:0xf bound_ctrl:0
    v_mov_b32_dpp v223, v217 row_shr:8 row_mask:0xf bank_mask:0xf bound_ctrl:0
    v_mov_b32_dpp v220, v217 row_shr:12 row_mask:0xf bank_mask:0xf bound_ctrl:0
    v_mov_b32_e64 v221, 0
    v_mov_b32_dpp v224, v227 row_shl:12 row_mask:0xf bank_mask:0xf bound_ctrl:0
    v_mov_b32_dpp v225, v227 row_shl:8 row_mask:0xf bank_mask:0xf bound_ctrl:0
    v_mov_b32_dpp v226, v227 row_shl:4 row_mask:0xf bank_mask:0xf bound_ctrl:0
    v_mov_b32_dpp v228, v227 row_shr:4 row_mask:0xf bank_mask:0xf bound_ctrl:0
    v_mov_b32_dpp v229, v227 row_shr:8 row_mask:0xf bank_mask:0xf bound_ctrl:0
    v_mov_b32_dpp v230, v227 row_shr:12 row_mask:0xf bank_mask:0xf bound_ctrl:0
    v_mov_b32_e64 v231, 0
    v_mov_b32_dpp v232, v235 row_shl:12 row_mask:0xf bank_mask:0xf bound_ctrl:0
    v_mov_b32_dpp v233, v235 row_shl:8 row_mask:0xf bank_mask:0xf bound_ctrl:0
    v_mov_b32_dpp v234, v235 row_shl:4 row_mask:0xf bank_mask:0xf bound_ctrl:0
    v_mov_b32_dpp v236, v235 row_shr:4 row_mask:0xf bank_mask:0xf bound_ctrl:0
    v_mov_b32_dpp v237, v235 row_shr:8 row_mask:0xf bank_mask:0xf bound_ctrl:0
    v_mov_b32_dpp v238, v235 row_shr:12 row_mask:0xf bank_mask:0xf bound_ctrl:0
    v_mov_b32_e64 v239, 0
    v_mov_b32_dpp v242, v241 row_shl:12 row_mask:0xf bank_mask:0xf bound_ctrl:0
    v_mov_b32_dpp v243, v241 row_shl:8 row_mask:0xf bank_mask:0xf bound_ctrl:0
    v_mov_b32_dpp v240, v241 row_shl:4 row_mask:0xf bank_mask:0xf bound_ctrl:0
    v_mov_b32_dpp v246, v241 row_shr:4 row_mask:0xf bank_mask:0xf bound_ctrl:0
    v_mov_b32_dpp v247, v241 row_shr:8 row_mask:0xf bank_mask:0xf bound_ctrl:0
    v_mov_b32_dpp v244, v241 row_shr:12 row_mask:0xf bank_mask:0xf bound_ctrl:0
    v_mov_b32_e64 v245, 0
    v_mov_b32_dpp v250, v249 row_shl:12 row_mask:0xf bank_mask:0xf bound_ctrl:0
    v_mov_b32_dpp v251, v249 row_shl:8 row_mask:0xf bank_mask:0xf bound_ctrl:0
    v_mov_b32_dpp v248, v249 row_shl:4 row_mask:0xf bank_mask:0xf bound_ctrl:0
    v_mov_b32_dpp v254, v249 row_shr:4 row_mask:0xf bank_mask:0xf bound_ctrl:0
    v_mov_b32_dpp v255, v249 row_shr:8 row_mask:0xf bank_mask:0xf bound_ctrl:0
    v_mov_b32_dpp v252, v249 row_shr:12 row_mask:0xf bank_mask:0xf bound_ctrl:0
    v_mov_b32 v253, 0
    s_cmp_lg_u32 s60, 7
    s_cbranch_scc1 L_sk12
    v_lshrrev_b32 v12, 2, v2
    v_mul_u32_u24 v12, 768, v12
    v_lshrrev_b32 v13, 5, v2
    v_lshlrev_b32 v13, 1, v13
    v_and_b32 v10, 3, v2
    v_xor_b32 v13, v13, v10
    v_lshl_add_u32 v4, v13, 4, v12
    v_mov_b32 v12, 162816
L_xq1:
    ds_read_b32 v13, v12 offset:16
    s_waitcnt lgkmcnt(0)
    v_readfirstlane_b32 s75, v13
    s_nop 1
    s_cmp_lt_u32 s75, 8
    s_cbranch_scc1 L_xq1
    s_mov_b32 s73, 0
    s_mov_b32 s74, 0
L_w1loop:
    s_add_u32 m0, s74, 36864
    s_add_u32 s75, s73, 384
    buffer_load_dwordx4 v4, s[32:35], s75 offen lds
    s_add_u32 m0, s74, 43008
    s_add_u32 s75, s73, 448
    buffer_load_dwordx4 v4, s[32:35], s75 offen lds
    s_add_u32 m0, s74, 49152
    s_add_u32 s75, s73, 512
    buffer_load_dwordx4 v4, s[32:35], s75 offen lds
    s_add_u32 m0, s74, 55296
    s_add_u32 s75, s73, 576
    buffer_load_dwordx4 v4, s[32:35], s75 offen lds
    s_add_u32 m0, s74, 61440
    s_add_u32 s75, s73, 640
    buffer_load_dwordx4 v4, s[32:35], s75 offen lds
    s_add_u32 m0, s74, 67584
    s_add_u32 s75, s73, 704
    buffer_load_dwordx4 v4, s[32:35], s75 offen lds
    s_add_u32 s73, s73, 12288
    s_add_u32 s74, s74, 1024
    s_cmp_lt_u32 s74, 6144
    s_cbranch_scc1 L_w1loop
    s_waitcnt vmcnt(36)
L_sk12:
    s_cmp_ge_u32 s60, 7
    s_cbranch_scc1 L_sk13
    s_cmp_ge_u32 s60, 6
    s_cbranch_scc1 L_sk14
    s_waitcnt vmcnt(8)
L_sk14:
    s_cmp_lg_u32 s60, 6
    s_cbranch_scc1 L_sk15
    s_waitcnt vmcnt(4)
L_sk15:
    s_mov_b32 exec_hi, 0x0fffffff
    v_perm_b32 v8, v20, v16, s65
    v_perm_b32 v9, v28, v24, s65
    ds_write_b64 v6, v[8:9] offset:0
    v_perm_b32 v10, v20, v16, s66
    v_perm_b32 v11, v28, v24, s66
    ds_write_b64 v7, v[10:11] offset:0
    v_perm_b32 v12, v21, v17, s65
    v_perm_b32 v13, v29, v25, s65
    ds_write_b64 v6, v[12:13] offset:320
    v_perm_b32 v14, v21, v17, s66
    v_perm_b32 v15, v29, v25, s66
    ds_write_b64 v7, v[14:15] offset:320
    v_perm_b32 v8, v22, v18, s65
    v_perm_b32 v9, v30, v26, s65
    ds_write_b64 v6, v[8:9] offset:640
    v_perm_b32 v10, v22, v18, s66
    v_perm_b32 v11, v30, v26, s66
    ds_write_b64 v7, v[10:11] offset:640
    v_perm_b32 v12, v23, v19, s65
    v_perm_b32 v13, v31, v27, s65
    ds_write_b64 v6, v[12:13] offset:960
    v_perm_b32 v14, v23, v19, s66
    v_perm_b32 v15, v31, v27, s66
    ds_write_b64 v7, v[14:15] offset:960
    s_mov_b32 exec_hi, -1
    s_cmp_ge_u32 s60, 6
    s_cbranch_scc1 L_sk16
    s_waitcnt vmcnt(4)
L_sk16:
    s_cmp_lg_u32 s60, 6
    s_cbranch_scc1 L_sk17
    s_waitcnt vmcnt(0)
L_sk17:
    v_add_u32 v6, s82, v6
    v_add_u32 v7, s82, v7
    s_mov_b32 exec_hi, 0x0fffffff
    v_perm_b32 v8, v36, v32, s65
    v_perm_b32 v9, v44, v40, s65
    ds_write_b64 v6, v[8:9] offset:0
    v_perm_b32 v10, v36, v32, s66
    v_perm_b32 v11, v44, v40, s66
    ds_write_b64 v7, v[10:11] offset:0
    v_perm_b32 v12, v37, v33, s65
    v_perm_b32 v13, v45, v41, s65
    ds_write_b64 v6, v[12:13] offset:320
    v_perm_b32 v14, v37, v33, s66
    v_perm_b32 v15, v45, v41, s66
    ds_write_b64 v7, v[14:15] offset:320
    v_perm_b32 v8, v38, v34, s65
    v_perm_b32 v9, v46, v42, s65
    ds_write_b64 v6, v[8:9] offset:640
    v_perm_b32 v10, v38, v34, s66
    v_perm_b32 v11, v46, v42, s66
    ds_write_b64 v7, v[10:11] offset:640
    v_perm_b32 v12, v39, v35, s65
    v_perm_b32 v13, v47, v43, s65
    ds_write_b64 v6, v[12:13] offset:960
    v_perm_b32 v14, v39, v35, s66
    v_perm_b32 v15, v47, v43, s66
    ds_write_b64 v7, v[14:15] offset:960
    s_mov_b32 exec_hi, -1
    s_cmp_ge_u32 s60, 6
    s_cbranch_scc1 L_sk18
    s_waitcnt vmcnt(0)
    v_add_u32 v6, s83, v6
    v_add_u32 v7, s83, v7
    s_mov_b32 exec_hi, 0x0fffffff
    v_perm_b32 v8, v52, v48, s65
    v_perm_b32 v9, v60, v56, s65
    ds_write_b64 v6, v[8:9] offset:0
    v_perm_b32 v10, v52, v48, s66
    v_perm_b32 v11, v60, v56, s66
    ds_write_b64 v7, v[10:11] offset:0
    v_perm_b32 v12, v53, v49, s65
    v_perm_b32 v13, v61, v57, s65
    ds_write_b64 v6, v[12:13] offset:320
    v_perm_b32 v14, v53, v49, s66
    v_perm_b32 v15, v61, v57, s66
    ds_write_b64 v7, v[14:15] offset:320
    v_perm_b32 v8, v54, v50, s65
    v_perm_b32 v9, v62, v58, s65
    ds_write_b64 v6, v[8:9] offset:640
    v_perm_b32 v10, v54, v50, s66
    v_perm_b32 v11, v62, v58, s66
    ds_write_b64 v7, v[10:11] offset:640
    v_perm_b32 v12, v55, v51, s65
    v_perm_b32 v13, v63, v59, s65
    ds_write_b64 v6, v[12:13] offset:960
    v_perm_b32 v14, v55, v51, s66
    v_perm_b32 v15, v63, v59, s66
    ds_write_b64 v7, v[14:15] offset:960
    s_mov_b32 exec_hi, -1
L_sk18:
L_sk13:
    v_and_b32 v8, 7, v2
    v_lshrrev_b32_e64 v9, 4, v2
    v_lshl_add_u32 v8, v8, 1, v9
    v_lshlrev_b32_e64 v8, 4, v8
    s_mul_i32 s70, s60, 1920
    s_mul_i32 s71, s60, 3
    s_lshr_b32 s71, s71, 1
    s_lshl_b32 s71, s71, 4
    s_add_u32 s70, s70, s71
    s_add_u32 s70, s70, 73728
    v_add_u32_e64 v8, s70, v8
    v_bfe_u32 v9, v2, 3, 1
    v_mul_u32_u24 v9, 15616, v9
    v_add_u32 v4, v8, v9
    v_sub_u32 v5, v8, v9
    v_add_u32 v5, 46848, v5
    s_and_b32 s71, s60, 1
    s_lshl_b32 s71, s71, 4
    s_waitcnt lgkmcnt(0)
    v_add_u32 v6, s71, v4
    v_add_u32 v7, s71, v5
    s_barrier
    ds_read_b128 v[16:19], v4 offset:0
    ds_read_b128 v[20:23], v4 offset:15616
    ds_read_b128 v[24:27], v4 offset:64
    ds_read_b128 v[28:31], v4 offset:15680
    ds_read_b128 v[32:35], v5 offset:15616
    ds_read_b128 v[36:39], v5 offset:0
    ds_read_b128 v[40:43], v5 offset:15680
    ds_read_b128 v[44:47], v5 offset:64
    s_waitcnt lgkmcnt(7)
    v_mfma_f32_16x16x32_bf16 v[12:15], v[16:19], v[64:67], 0
    ds_read_b128 v[48:51], v4 offset:320
    ds_read_b128 v[52:55], v4 offset:15936
    s_waitcnt lgkmcnt(8)
    v_mfma_f32_16x16x32_bf16 v[12:15], v[20:23], v[68:71], v[12:15]
    s_waitcnt lgkmcnt(6)
    v_mfma_f32_16x16x32_bf16 v[12:15], v[24:27], v[72:75], v[12:15]
    ds_read_b128 v[56:59], v4 offset:384
    ds_read_b128 v[60:63], v4 offset:16000
    v_mfma_f32_16x16x32_bf16 v[12:15], v[28:31], v[76:79], v[12:15]
    s_waitcnt lgkmcnt(6)
    v_mfma_f32_16x16x32_bf16 v[64:67], v[32:35], v[80:83], 0
    ds_read_b128 v[16:19], v5 offset:15936
    ds_read_b128 v[20:23], v5 offset:320
    v_mfma_f32_16x16x32_bf16 v[64:67], v[36:39], v[84:87], v[64:67]
    s_waitcnt lgkmcnt(6)
    v_mfma_f32_16x16x32_bf16 v[64:67], v[40:43], v[88:91], v[64:67]
    ds_read_b128 v[24:27], v5 offset:16000
    ds_read_b128 v[28:31], v5 offset:384
    v_mfma_f32_16x16x32_bf16 v[64:67], v[44:47], v[92:95], v[64:67]
    s_waitcnt lgkmcnt(6)
    v_mfma_f32_16x16x32_bf16 v[80:83], v[48:51], v[96:99], 0
    ds_read_b128 v[32:35], v6 offset:640
    ds_read_b128 v[36:39], v6 offset:16256
    v_mul_f32 v72, v12, v12
    v_mul_f32 v73, v13, v13
    v_mfma_f32_16x16x32_bf16 v[80:83], v[52:55], v[100:103], v[80:83]
    s_waitcnt lgkmcnt(6)
    v_mul_f32 v74, v14, v14
    v_mul_f32_e64 v75, v15, v15
    v_mfma_f32_16x16x32_bf16 v[80:83], v[56:59], v[104:107], v[80:83]
    ds_read_b128 v[40:43], v6 offset:704
    ds_read_b128 v[44:47], v6 offset:16320
    v_mfma_f32_16x16x32_bf16 v[80:83], v[60:63], v[108:111], v[80:83]
    s_waitcnt lgkmcnt(6)
    v_mfma_f32_16x16x32_bf16 v[96:99], v[16:19], v[112:115], 0
    ds_read_b128 v[48:51], v7 offset:16256
    ds_read_b128 v[52:55], v7 offset:640
    v_add_f32 v68, v64, v12
    v_fmac_f32_e64 v72, v64, v64
    v_mfma_f32_16x16x32_bf16 v[96:99], v[20:23], v[116:119], v[96:99]
    s_waitcnt lgkmcnt(6)
    v_add_f32 v69, v65, v13
    v_fmac_f32_e64 v73, v65, v65
    v_mfma_f32_16x16x32_bf16 v[96:99], v[24:27], v[120:123], v[96:99]
    ds_read_b128 v[56:59], v7 offset:16320
    ds_read_b128 v[60:63], v7 offset:704
    v_add_f32 v70, v66, v14
    v_fmac_f32 v74, v66, v66
    v_mfma_f32_16x16x32_bf16 v[96:99], v[28:31], v[124:127], v[96:99]
    s_waitcnt lgkmcnt(6)
    v_add_f32 v71, v67, v15
    v_fmac_f32_e64 v75, v67, v67
    v_mfma_f32_16x16x32_bf16 v[112:115], v[32:35], v[128:131], 0
    ds_read_b128 v[16:19], v6 offset:960
    ds_read_b128 v[20:23], v6 offset:16576
    v_add_f32 v68, v80, v68
    v_fmac_f32 v72, v80, v80
    v_mfma_f32_16x16x32_bf16 v[112:115], v[36:39], v[132:135], v[112:115]
    s_waitcnt lgkmcnt(6)
    v_add_f32 v69, v81, v69
    v_fmac_f32_e64 v73, v81, v81
    v_mfma_f32_16x16x32_bf16 v[112:115], v[40:43], v[136:139], v[112:115]
    ds_read_b128 v[24:27], v6 offset:1024
    ds_read_b128 v[28:31], v6 offset:16640
    v_add_f32 v70, v82, v70
    v_fmac_f32 v74, v82, v82
    v_mfma_f32_16x16x32_bf16 v[112:115], v[44:47], v[140:143], v[112:115]
    s_waitcnt lgkmcnt(6)
    v_add_f32 v71, v83, v71
    v_fmac_f32_e64 v75, v83, v83
    v_mfma_f32_16x16x32_bf16 v[128:131], v[48:51], v[144:147], 0
    ds_read_b128 v[32:35], v7 offset:16576
    ds_read_b128 v[36:39], v7 offset:960
    v_add_f32 v68, v96, v68
    v_fmac_f32 v72, v96, v96
    v_mfma_f32_16x16x32_bf16 v[128:131], v[52:55], v[148:151], v[128:131]
    s_waitcnt lgkmcnt(6)
    v_add_f32 v69, v97, v69
    v_fmac_f32_e64 v73, v97, v97
    v_mfma_f32_16x16x32_bf16 v[128:131], v[56:59], v[152:155], v[128:131]
    ds_read_b128 v[40:43], v7 offset:16640
    ds_read_b128 v[44:47], v7 offset:1024
    v_add_f32 v70, v98, v70
    v_fmac_f32 v74, v98, v98
    v_mfma_f32_16x16x32_bf16 v[128:131], v[60:63], v[156:159], v[128:131]
    s_waitcnt lgkmcnt(6)
    v_add_f32 v71, v99, v71
    v_fmac_f32_e64 v75, v99, v99
    v_mfma_f32_16x16x32_bf16 v[144:147], v[16:19], v[160:163], 0
    ds_read_b128 v[48:51], v4 offset:1296
    ds_read_b128 v[52:55], v4 offset:16912
    v_add_f32 v68, v112, v68
    v_fmac_f32 v72, v112, v112
    v_mfma_f32_16x16x32_bf16 v[144:147], v[20:23], v[164:167], v[144:147]
    s_waitcnt lgkmcnt(6)
    v_add_f32 v69, v113, v69
    v_fmac_f32_e64 v73, v113, v113
    v_mfma_f32_16x16x32_bf16 v[144:147], v[24:27], v[168:171], v[144:147]
    ds_read_b128 v[56:59], v4 offset:1360
    ds_read_b128 v[60:63], v4 offset:16976
    v_add_f32 v70, v114, v70
    v_fmac_f32 v74, v114, v114
    v_mfma_f32_16x16x32_bf16 v[144:147], v[28:31], v[172:175], v[144:147]
    s_waitcnt lgkmcnt(6)
    v_add_f32 v71, v115, v71
    v_fmac_f32_e64 v75, v115, v115
    v_mfma_f32_16x16x32_bf16 v[160:163], v[32:35], v[176:179], 0
    ds_read_b128 v[16:19], v5 offset:16912
    ds_read_b128 v[20:23], v5 offset:1296
    v_add_f32 v68, v128, v68
    v_fmac_f32 v72, v128, v128
    v_mfma_f32_16x16x32_bf16 v[160:163], v[36:39], v[180:183], v[160:163]
    s_waitcnt lgkmcnt(6)
    v_add_f32 v69, v129, v69
    v_fmac_f32_e64 v73, v129, v129
    v_mfma_f32_16x16x32_bf16 v[160:163], v[40:43], v[184:187], v[160:163]
    ds_read_b128 v[24:27], v5 offset:16976
    ds_read_b128 v[28:31], v5 offset:1360
    v_add_f32 v70, v130, v70
    v_fmac_f32 v74, v130, v130
    v_mfma_f32_16x16x32_bf16 v[160:163], v[44:47], v[188:191], v[160:163]
    s_waitcnt lgkmcnt(6)
    v_add_f32 v71, v131, v71
    v_fmac_f32_e64 v75, v131, v131
    v_mfma_f32_16x16x32_bf16 v[176:179], v[48:51], v[192:195], 0
    ds_read_b128 v[32:35], v4 offset:1616
    ds_read_b128 v[36:39], v4 offset:17232
    v_add_f32 v68, v144, v68
    v_fmac_f32 v72, v144, v144
    v_mfma_f32_16x16x32_bf16 v[176:179], v[52:55], v[196:199], v[176:179]
    s_waitcnt lgkmcnt(6)
    v_add_f32 v69, v145, v69
    v_fmac_f32_e64 v73, v145, v145
    v_mfma_f32_16x16x32_bf16 v[176:179], v[56:59], v[200:203], v[176:179]
    ds_read_b128 v[40:43], v4 offset:1680
    ds_read_b128 v[44:47], v4 offset:17296
    v_add_f32 v70, v146, v70
    v_fmac_f32 v74, v146, v146
    v_mfma_f32_16x16x32_bf16 v[176:179], v[60:63], v[204:207], v[176:179]
    s_waitcnt lgkmcnt(6)
    v_add_f32 v71, v147, v71
    v_fmac_f32_e64 v75, v147, v147
    v_mfma_f32_16x16x32_bf16 v[192:195], v[16:19], v[208:211], 0
    ds_read_b128 v[48:51], v5 offset:17232
    ds_read_b128 v[52:55], v5 offset:1616
    v_add_f32 v68, v160, v68
    v_fmac_f32 v72, v160, v160
    v_mfma_f32_16x16x32_bf16 v[192:195], v[20:23], v[212:215], v[192:195]
    s_waitcnt lgkmcnt(6)
    v_add_f32 v69, v161, v69
    v_fmac_f32_e64 v73, v161, v161
    v_mfma_f32_16x16x32_bf16 v[192:195], v[24:27], v[216:219], v[192:195]
    ds_read_b128 v[56:59], v5 offset:17296
    ds_read_b128 v[60:63], v5 offset:1680
    v_add_f32 v70, v162, v70
    v_fmac_f32 v74, v162, v162
    v_mfma_f32_16x16x32_bf16 v[192:195], v[28:31], v[220:223], v[192:195]
    s_waitcnt lgkmcnt(6)
    v_add_f32 v71, v163, v71
    v_fmac_f32_e64 v75, v163, v163
    v_mfma_f32_16x16x32_bf16 v[208:211], v[32:35], v[224:227], 0
    v_add_f32 v68, v176, v68
    v_fmac_f32 v72, v176, v176
    v_mfma_f32_16x16x32_bf16 v[208:211], v[36:39], v[228:231], v[208:211]
    s_waitcnt lgkmcnt(4)
    v_add_f32 v69, v177, v69
    v_fmac_f32_e64 v73, v177, v177
    v_mfma_f32_16x16x32_bf16 v[208:211], v[40:43], v[232:235], v[208:211]
    v_add_f32 v70, v178, v70
    v_fmac_f32 v74, v178, v178
    v_mfma_f32_16x16x32_bf16 v[208:211], v[44:47], v[236:239], v[208:211]
    s_waitcnt lgkmcnt(2)
    v_add_f32 v71, v179, v71
    v_fmac_f32_e64 v75, v179, v179
    v_mfma_f32_16x16x32_bf16 v[224:227], v[48:51], v[240:243], 0
    v_add_f32 v68, v192, v68
    v_fmac_f32 v72, v192, v192
    v_mfma_f32_16x16x32_bf16 v[224:227], v[52:55], v[244:247], v[224:227]
    s_waitcnt lgkmcnt(0)
    v_add_f32 v69, v193, v69
    v_fmac_f32_e64 v73, v193, v193
    v_mfma_f32_16x16x32_bf16 v[224:227], v[56:59], v[248:251], v[224:227]
    v_add_f32 v70, v194, v70
    v_fmac_f32 v74, v194, v194
    v_mfma_f32_16x16x32_bf16 v[224:227], v[60:63], v[252:255], v[224:227]
    v_add_f32 v71, v195, v71
    v_fmac_f32 v75, v195, v195
    v_add_f32 v68, v208, v68
    v_fmac_f32 v72, v208, v208
    v_add_f32 v69, v209, v69
    v_fmac_f32 v73, v209, v209
    v_add_f32 v70, v210, v70
    v_fmac_f32 v74, v210, v210
    v_add_f32 v71, v211, v71
    v_fmac_f32 v75, v211, v211
    v_lshlrev_b32 v8, 4, v2
    v_add_u32 v9, s70, v8
    v_add_u32 v11, 151808, v8
    v_add_f32 v68, v224, v68
    v_fmac_f32 v72, v224, v224
    v_add_f32 v69, v225, v69
    v_fmac_f32 v73, v225, v225
    v_add_f32 v70, v226, v70
    v_fmac_f32 v74, v226, v226
    v_add_f32 v71, v227, v71
    v_fmac_f32 v75, v227, v227
    ds_write_b128 v9, v[68:71]
    ds_write_b128 v9, v[72:75] offset:15616
    s_mov_b32 s72, 73728
    v_bfe_u32 v4, v2, 4, 1
    v_and_b32_e64 v5, 1, v2
    v_lshl_add_u32 v4, v4, 3, v5
    v_mul_u32_u24 v4, 14, v4
    v_lshrrev_b32 v5, 5, v2
    v_lshl_add_u32 v4, v5, 3, v4
    v_bfe_u32 v5, v2, 1, 3
    v_add_u32_e64 v4, v4, v5
    v_mul_u32_u24 v4, 208, v4
    s_mul_i32 s71, s60, 24
    s_add_u32 s71, s71, 103968
    v_add_u32 v4, s71, v4
    v_and_b32 v8, 31, v2
    s_lshl_b32 s71, s60, 7
    v_lshl_add_u32 v8, v8, 2, s71
    v_lshrrev_b32_e64 v5, 5, v2
    v_lshl_add_u32 v10, v5, 10, v8
    v_add_u32 v10, 151808, v10
    v_mul_u32_u24 v5, 15616, v5
    v_add3_u32 v8, v8, v5, s72
    s_cmp_ge_u32 s60, 4
    s_cbranch_scc1 L_sk19
    v_lshrrev_b32_e64 v16, 2, v2
    v_mul_u32_u24 v16, 768, v16
    v_lshrrev_b32 v17, 5, v2
    v_lshlrev_b32 v17, 1, v17
    v_and_b32 v18, 3, v2
    v_xor_b32 v17, v17, v18
    v_lshl_add_u32 v16, v17, 4, v16
    s_mul_i32 s74, s60, 9216
    s_mul_i32 s73, s60, 3
    s_lshr_b32 s73, s73, 1
    s_lshl_b32 s73, s73, 6
    s_bitcmp1_b32 s60, 0
    s_cselect_b32 s76, 36864, 0
    s_cselect_b32 s77, 64, 36864
    s_cselect_b32 s78, 36928, 64
    s_add_u32 s76, s76, s73
    s_add_u32 s77, s77, s73
    s_add_u32 s78, s78, s73
    s_add_u32 m0, s74, 0
    s_add_u32 s75, s76, 0
    buffer_load_dwordx4 v16, s[32:35], s75 offen lds
    s_add_u32 m0, s74, 1024
    s_add_u32 s75, s76, 12288
    buffer_load_dwordx4 v16, s[32:35], s75 offen lds
    s_add_u32 m0, s74, 2048
    s_add_u32 s75, s76, 24576
    buffer_load_dwordx4 v16, s[32:35], s75 offen lds
    s_add_u32 m0, s74, 3072
    s_add_u32 s75, s77, 0
    buffer_load_dwordx4 v16, s[32:35], s75 offen lds
    s_add_u32 m0, s74, 4096
    s_add_u32 s75, s77, 12288
    buffer_load_dwordx4 v16, s[32:35], s75 offen lds
    s_add_u32 m0, s74, 5120
    s_add_u32 s75, s77, 24576
    buffer_load_dwordx4 v16, s[32:35], s75 offen lds
    s_add_u32 m0, s74, 6144
    s_add_u32 s75, s78, 0
    buffer_load_dwordx4 v16, s[32:35], s75 offen lds
    s_add_u32 m0, s74, 7168
    s_add_u32 s75, s78, 12288
    buffer_load_dwordx4 v16, s[32:35], s75 offen lds
    s_add_u32 m0, s74, 8192
    s_add_u32 s75, s78, 24576
    buffer_load_dwordx4 v16, s[32:35], s75 offen lds
L_sk19:
    s_waitcnt lgkmcnt(0)
    s_barrier
    ds_read_b32 v16, v8 offset:0
    ds_read_b32 v17, v8 offset:1936
    ds_read_b32 v18, v8 offset:3888
    ds_read_b32 v19, v8 offset:5824
    ds_read_b32 v20, v8 offset:7776
    ds_read_b32 v21, v8 offset:9712
    ds_read_b32 v22, v8 offset:11664
    ds_read_b32 v23, v8 offset:13600
    s_waitcnt lgkmcnt(6)
    v_add_f32 v16, v16, v17
    s_waitcnt lgkmcnt(4)
    v_add_f32 v18, v18, v19
    s_waitcnt lgkmcnt(2)
    v_add_f32 v20, v20, v21
    s_waitcnt lgkmcnt(0)
    v_add_f32 v22, v22, v23
    v_add_f32 v16, v16, v18
    v_add_f32 v20, v20, v22
    v_add_f32 v16, v16, v20
    v_mul_f32 v16, 0x3c2aaaab, v16
    v_mov_b32 v17, v16
    s_nop 1
    v_permlane32_swap_b32_e64 v16, v17
    v_fma_f32 v17, -v16, v16, v17
    v_max_f32_e64 v17, 0, v17
    v_add_f32 v17, 0x3727c5ac, v17
    v_rsq_f32 v17, v17
    s_nop 0
    v_mul_f32 v17, 0x3eeff558, v17
    v_mul_f32 v16, -v16, v17
    s_nop 1
    v_permlane32_swap_b32 v17, v16
    ds_write_b32 v10, v17
    s_waitcnt lgkmcnt(0)
    s_barrier
    ds_read_b128 v[24:27], v11
    ds_read_b128 v[28:31], v11 offset:1024
    s_and_b32 s82, s60, 1
    s_lshr_b32 s71, s60, 1
    s_mul_i32 s71, s71, 3
    s_cmp_eq_u32 s82, 0
    s_cselect_b32 s84, 0, 2
    s_cselect_b32 s85, 1, 0
    s_cselect_b32 s86, 2, 1
    s_add_u32 s84, s84, s71
    s_add_u32 s85, s85, s71
    s_add_u32 s86, s86, s71
    s_movk_i32 s72, 208
    v_lshrrev_b32 v7, 5, v2
    v_lshlrev_b32 v5, 4, v7
    v_and_b32 v6, 31, v2
    s_mul_i32 s71, s82, 19968
    s_add_u32 s71, s71, 103968
    v_mad_u32_u24 v8, v6, s72, v5
    v_add_u32_e64 v8, s71, v8
    v_add_u32 v5, 143904, v5
    v_min_u32_e64 v9, 15, v6
    v_mad_u32_u24 v9, v9, s72, v5
    s_lshl_b32 s71, s82, 6
    s_sub_u32 s71, s71, 4
    v_add_u32 v1, s71, v6
    v_min_u32 v1, 15, v1
    v_mad_u32_u24 v1, v1, s72, v5
    v_bfe_u32 v5, v2, 4, 1
    v_xor_b32 v5, v5, v7
    v_lshlrev_b32 v10, 9, v7
    v_lshl_add_u32 v10, v5, 5, v10
    v_bfe_u32 v5, v2, 2, 2
    v_lshl_add_u32 v10, v5, 6, v10
    v_and_b32_e64 v5, 3, v2
    v_lshl_add_u32 v10, v5, 3, v10
    s_waitcnt lgkmcnt(0)
    v_pk_fma_f32 v[12:13], v[12:13], v[24:25], v[28:29]
    v_pk_fma_f32 v[64:65], v[64:65], v[24:25], v[28:29]
    v_pk_fma_f32 v[80:81], v[80:81], v[24:25], v[28:29]
    v_pk_fma_f32 v[96:97], v[96:97], v[24:25], v[28:29]
    v_pk_fma_f32 v[112:113], v[112:113], v[24:25], v[28:29]
    v_pk_fma_f32 v[128:129], v[128:129], v[24:25], v[28:29]
    v_pk_fma_f32 v[144:145], v[144:145], v[24:25], v[28:29]
    v_pk_fma_f32 v[160:161], v[160:161], v[24:25], v[28:29]
    v_pk_fma_f32 v[176:177], v[176:177], v[24:25], v[28:29]
    v_pk_fma_f32 v[192:193], v[192:193], v[24:25], v[28:29]
    v_pk_fma_f32 v[208:209], v[208:209], v[24:25], v[28:29]
    v_pk_fma_f32 v[224:225], v[224:225], v[24:25], v[28:29]
    v_cvt_pk_bf16_f32 v32, v12, v64
    v_cvt_pk_bf16_f32 v33, v80, v96
    v_cvt_pk_bf16_f32 v34, v112, v128
    v_cvt_pk_bf16_f32 v35, v144, v160
    v_cvt_pk_bf16_f32 v36, v176, v192
    v_cvt_pk_bf16_f32 v37, v208, v224
    v_cvt_pk_bf16_f32 v40, v13, v65
    v_cvt_pk_bf16_f32 v41, v81, v97
    v_cvt_pk_bf16_f32 v42, v113, v129
    v_cvt_pk_bf16_f32 v43, v145, v161
    v_cvt_pk_bf16_f32 v44, v177, v193
    v_cvt_pk_bf16_f32 v45, v209, v225
    s_mov_b32 exec_hi, 0x0fff0fff
    s_bitcmp1_b32 s60, 0
    s_cbranch_scc1 L_yo0
    ds_write_b128 v4, v[32:35] offset:0
    ds_write_b64 v4, v[36:37] offset:16
    ds_write_b128 v4, v[40:43] offset:5824
    ds_write_b64 v4, v[44:45] offset:5840
    s_branch L_yd0
L_yo0:
    ds_write_b64 v4, v[32:33] offset:0
    ds_write_b128 v4, v[34:37] offset:8
    ds_write_b64 v4, v[40:41] offset:5824
    ds_write_b128 v4, v[42:45] offset:5832
L_yd0:
    s_mov_b32 exec_hi, -1
    v_pk_fma_f32 v[14:15], v[14:15], v[26:27], v[30:31]
    v_pk_fma_f32 v[66:67], v[66:67], v[26:27], v[30:31]
    v_pk_fma_f32 v[82:83], v[82:83], v[26:27], v[30:31]
    v_pk_fma_f32 v[98:99], v[98:99], v[26:27], v[30:31]
    v_pk_fma_f32 v[114:115], v[114:115], v[26:27], v[30:31]
    v_pk_fma_f32 v[130:131], v[130:131], v[26:27], v[30:31]
    v_pk_fma_f32 v[146:147], v[146:147], v[26:27], v[30:31]
    v_pk_fma_f32 v[162:163], v[162:163], v[26:27], v[30:31]
    v_pk_fma_f32 v[178:179], v[178:179], v[26:27], v[30:31]
    v_pk_fma_f32 v[194:195], v[194:195], v[26:27], v[30:31]
    v_pk_fma_f32 v[210:211], v[210:211], v[26:27], v[30:31]
    v_pk_fma_f32 v[226:227], v[226:227], v[26:27], v[30:31]
    v_cvt_pk_bf16_f32 v48, v14, v66
    v_cvt_pk_bf16_f32 v49, v82, v98
    v_cvt_pk_bf16_f32 v50, v114, v130
    v_cvt_pk_bf16_f32 v51, v146, v162
    v_cvt_pk_bf16_f32 v52, v178, v194
    v_cvt_pk_bf16_f32 v53, v210, v226
    v_cvt_pk_bf16_f32 v56, v15, v67
    v_cvt_pk_bf16_f32 v57, v83, v99
    v_cvt_pk_bf16_f32 v58, v115, v131
    v_cvt_pk_bf16_f32 v59, v147, v163
    v_cvt_pk_bf16_f32 v60, v179, v195
    v_cvt_pk_bf16_f32 v61, v211, v227
    s_mov_b32 exec_lo, 0xffff0000
    s_mov_b32 exec_hi, 0xffff0000
    v_mov_b32 v56, 0
    v_mov_b32 v57, 0
    v_mov_b32 v58, 0
    v_mov_b32 v59, 0
    v_mov_b32 v60, 0
    v_mov_b32 v61, 0
    s_mov_b32 exec_lo, -1
    s_mov_b32 exec_hi, 0x0fff0fff
    s_bitcmp1_b32 s60, 0
    s_cbranch_scc1 L_yo2
    ds_write_b128 v4, v[48:51] offset:11648
    ds_write_b64 v4, v[52:53] offset:11664
    ds_write_b128 v4, v[56:59] offset:17472
    ds_write_b64 v4, v[60:61] offset:17488
    s_branch L_yd2
L_yo2:
    ds_write_b64 v4, v[48:49] offset:11648
    ds_write_b128 v4, v[50:53] offset:11656
    ds_write_b64 v4, v[56:57] offset:17472
    ds_write_b128 v4, v[58:61] offset:17480
L_yd2:
    s_mov_b32 exec_hi, -1
    s_mul_i32 s88, s84, 6144
    s_lshl_b32 s91, s84, 7
    s_mul_i32 s89, s85, 6144
    s_lshl_b32 s92, s85, 7
    s_mul_i32 s90, s86, 6144
    s_lshl_b32 s93, s86, 7
    s_waitcnt vmcnt(0) lgkmcnt(0)
    v_add_u32 v4, s88, v10
    s_setprio 1
    s_cmp_ge_u32 s60, 4
    s_cbranch_scc1 L_sk20
    s_setprio 2
L_sk20:
    s_barrier
    ds_read_b128 v[16:19], v8 offset:0
    ds_read_b64_tr_b16 v[88:89], v4 offset:0
    ds_read_b64_tr_b16 v[90:91], v4 offset:256
    ds_read_b128 v[20:23], v8 offset:32
    ds_read_b64_tr_b16 v[92:93], v4 offset:1024
    ds_read_b64_tr_b16 v[94:95], v4 offset:1280
    ds_read_b128 v[24:27], v8 offset:64
    ds_read_b64_tr_b16 v[96:97], v4 offset:2048
    ds_read_b64_tr_b16 v[98:99], v4 offset:2304
    ds_read_b128 v[28:31], v8 offset:96
    ds_read_b64_tr_b16 v[100:101], v4 offset:3072
    ds_read_b64_tr_b16 v[102:103], v4 offset:3328
    ds_read_b128 v[32:35], v8 offset:128
    ds_read_b64_tr_b16 v[104:105], v4 offset:4096
    ds_read_b64_tr_b16 v[106:107], v4 offset:4352
    v_lshlrev_b32_e64 v15, 2, v2
    v_and_b32 v12, 124, v15
    s_sub_u32 s71, s92, s91
    s_lshl_b32 s72, s82, 20
    s_add_u32 s71, s71, s72
    v_mad_i32_i24 v11, v7, s71, v12
    v_add_u32 v11, s91, v11
    v_lshlrev_b32_e64 v5, 1, v11
    v_add_u32 v5, 155136, v5
    v_add_u32 v11, 153600, v11
    s_movk_i32 s72, 1536
    v_mad_u32_u24 v12, v7, s72, v12
    s_mul_i32 s71, s82, 3072
    s_add_u32 s71, s71, 147456
    v_add_u32 v12, s71, v12
    s_mul_i32 s71, s61, 224
    s_add_u32 s71, s71, s62
    s_mul_i32 s4, s71, 192
    v_mov_b32 v14, 162820
    v_mov_b32 v13, 1
    v_lshl_add_u32 v6, v2, 20, v14
    s_cmp_lg_u32 s60, 3
    s_cbranch_scc1 L_sk21
    v_mov_b32 v184, -1
    v_mov_b32 v185, -1
    v_mov_b32 v186, -1
    v_mov_b32 v187, -1
    v_lshrrev_b32 v188, 2, v2
    v_lshlrev_b32 v188, 14, v188
    v_and_b32_e64 v189, 3, v2
    v_lshl_add_u32 v188, v189, 4, v188
    s_lshl_b32 s73, s81, 6
    s_add_u32 s74, s73, 262144
    buffer_store_dwordx4 v[184:187], v188, s[44:47], s73 offen
    s_mov_b32 exec_hi, 0
    buffer_store_dwordx4 v[184:187], v188, s[44:47], s74 offen
    s_mov_b32 exec_lo, 15
    s_min_u32 s75, s2, 191
    s_lshl_b32 s73, s75, 6
    s_add_u32 s73, s73, 1048576
    s_and_b32 s74, s75, 7
    s_lshl_b32 s74, s74, 11
    s_lshr_b32 s75, s75, 3
    s_lshl_b32 s75, s75, 6
    s_add_u32 s74, s74, s75
    s_add_u32 s74, s74, 1114112
    buffer_store_dwordx4 v[184:187], v188, s[44:47], s73 offen sc1
    buffer_store_dwordx4 v[184:187], v188, s[44:47], s74 offen sc1
    s_mov_b64 exec, -1
L_sk21:
    s_waitcnt lgkmcnt(12)
    v_mfma_f32_32x32x16_bf16 v[112:127], v[16:19], v[88:91], 0
    ds_read_b128 v[36:39], v8 offset:160
    ds_read_b64_tr_b16 v[108:109], v4 offset:5120
    ds_read_b64_tr_b16 v[110:111], v4 offset:5376
    s_waitcnt lgkmcnt(12)
    v_mfma_f32_32x32x16_bf16 v[112:127], v[20:23], v[92:95], v[112:127]
    ds_read_b128 v[192:195], v9 offset:0
    ds_read_b128 v[40:43], v8 offset:6656
    ds_read_b128 v[44:47], v8 offset:6688
    s_waitcnt lgkmcnt(12)
    v_mfma_f32_32x32x16_bf16 v[112:127], v[24:27], v[96:99], v[112:127]
    ds_read_b128 v[48:51], v8 offset:6720
    ds_read_b128 v[52:55], v8 offset:6752
    ds_read_b128 v[56:59], v8 offset:6784
    s_waitcnt lgkmcnt(12)
    v_mfma_f32_32x32x16_bf16 v[112:127], v[28:31], v[100:103], v[112:127]
    ds_read_b128 v[60:63], v8 offset:6816
    ds_read_b128 v[196:199], v9 offset:32
    ds_read_b128 v[200:203], v9 offset:64
    s_waitcnt lgkmcnt(12)
    v_mfma_f32_32x32x16_bf16 v[112:127], v[32:35], v[104:107], v[112:127]
    ds_read_b128 v[204:207], v9 offset:96
    ds_read_b128 v[64:67], v8 offset:13312
    ds_read_b128 v[68:71], v8 offset:13344
    s_waitcnt lgkmcnt(12)
    v_mfma_f32_32x32x16_bf16 v[112:127], v[36:39], v[108:111], v[112:127]
    ds_read_b128 v[72:75], v8 offset:13376
    ds_read_b128 v[76:79], v8 offset:13408
    ds_read_b128 v[80:83], v8 offset:13440
    s_nop 8
    v_pk_fma_f32 v[160:161], v[112:113], v[112:113], s[68:69]
    v_pk_fma_f32 v[162:163], v[114:115], v[114:115], s[68:69]
    v_pk_fma_f32 v[164:165], v[116:117], v[116:117], s[68:69]
    v_pk_fma_f32 v[166:167], v[118:119], v[118:119], s[68:69]
    v_pk_mul_f32 v[160:161], v[160:161], v[112:113] neg_lo:[1,0] neg_hi:[1,0]
    v_pk_mul_f32 v[162:163], v[162:163], v[114:115] neg_lo:[1,0] neg_hi:[1,0]
    v_pk_mul_f32 v[164:165], v[164:165], v[116:117] neg_lo:[1,0] neg_hi:[1,0]
    v_pk_mul_f32 v[166:167], v[166:167], v[118:119] neg_lo:[1,0] neg_hi:[1,0]
    s_waitcnt lgkmcnt(14)
    v_mfma_f32_32x32x16_bf16 v[240:255], v[192:195], v[88:91], 0
    ds_read_b128 v[84:87], v8 offset:13472
    ds_read_b128 v[208:211], v9 offset:128
    ds_read_b128 v[212:215], v9 offset:160
    v_exp_f32 v160, v160
    v_exp_f32 v161, v161
    v_exp_f32 v162, v162
    s_waitcnt lgkmcnt(15)
    v_mfma_f32_32x32x16_bf16 v[128:143], v[40:43], v[88:91], 0
    ds_read_b128 v[216:219], v1 offset:0
    ds_read_b128 v[220:223], v1 offset:32
    ds_read_b128 v[224:227], v1 offset:64
    v_exp_f32 v163, v163
    v_exp_f32 v164, v164
    v_exp_f32_e64 v165, v165
    v_mfma_f32_32x32x16_bf16 v[128:143], v[44:47], v[92:95], v[128:143]
    ds_read_b128 v[228:231], v1 offset:96
    ds_read_b128 v[232:235], v1 offset:128
    ds_read_b128 v[236:239], v1 offset:160
    v_exp_f32 v166, v166
    v_exp_f32_e64 v167, v167
    s_waitcnt lgkmcnt(15)
    v_mfma_f32_32x32x16_bf16 v[128:143], v[48:51], v[96:99], v[128:143]
    ds_add_u32 v6, v13
    v_pk_add_f32 v[160:161], v[160:161], 1.0 op_sel_hi:[1,0]
    v_pk_add_f32 v[162:163], v[162:163], 1.0 op_sel_hi:[1,0]
    v_pk_add_f32 v[164:165], v[164:165], 1.0 op_sel_hi:[1,0]
    v_pk_add_f32 v[166:167], v[166:167], 1.0 op_sel_hi:[1,0]
    v_pk_fma_f32 v[168:169], v[120:121], v[120:121], s[68:69]
    v_pk_fma_f32 v[170:171], v[122:123], v[122:123], s[68:69]
    v_pk_fma_f32 v[172:173], v[124:125], v[124:125], s[68:69]
    v_pk_fma_f32 v[174:175], v[126:127], v[126:127], s[68:69]
    v_pk_mul_f32 v[168:169], v[168:169], v[120:121] neg_lo:[1,0] neg_hi:[1,0]
    v_pk_mul_f32 v[170:171], v[170:171], v[122:123] neg_lo:[1,0] neg_hi:[1,0]
    v_pk_mul_f32 v[172:173], v[172:173], v[124:125] neg_lo:[1,0] neg_hi:[1,0]
    v_pk_mul_f32 v[174:175], v[174:175], v[126:127] neg_lo:[1,0] neg_hi:[1,0]
    v_mfma_f32_32x32x16_bf16 v[240:255], v[196:199], v[92:95], v[240:255]
    v_rcp_f32 v160, v160
    v_rcp_f32 v161, v161
    v_rcp_f32_e64 v162, v162
    v_mfma_f32_32x32x16_bf16 v[128:143], v[52:55], v[100:103], v[128:143]
    v_rcp_f32 v163, v163
    v_rcp_f32 v164, v164
    v_rcp_f32_e64 v165, v165
    v_mfma_f32_32x32x16_bf16 v[128:143], v[56:59], v[104:107], v[128:143]
    v_rcp_f32 v166, v166
    v_rcp_f32 v167, v167
    v_exp_f32_e64 v168, v168
    v_mfma_f32_32x32x16_bf16 v[128:143], v[60:63], v[108:111], v[128:143]
    v_exp_f32 v169, v169
    v_exp_f32 v170, v170
    v_exp_f32 v171, v171
    v_exp_f32 v172, v172
    v_exp_f32 v173, v173
    v_exp_f32 v174, v174
    v_exp_f32_e64 v175, v175
    v_pk_mul_f32 v[112:113], v[112:113], v[160:161]
    v_pk_mul_f32 v[114:115], v[114:115], v[162:163]
    v_pk_mul_f32 v[116:117], v[116:117], v[164:165]
    v_pk_mul_f32 v[118:119], v[118:119], v[166:167]
    v_pk_add_f32 v[168:169], v[168:169], 1.0 op_sel_hi:[1,0]
    v_pk_add_f32 v[170:171], v[170:171], 1.0 op_sel_hi:[1,0]
    v_pk_add_f32 v[172:173], v[172:173], 1.0 op_sel_hi:[1,0]
    v_pk_add_f32 v[174:175], v[174:175], 1.0 op_sel_hi:[1,0]
    v_pk_mul_f32 v[176:177], v[112:113], v[112:113]
    v_pk_fma_f32 v[176:177], v[114:115], v[114:115], v[176:177]
    v_pk_fma_f32 v[176:177], v[116:117], v[116:117], v[176:177]
    v_pk_fma_f32 v[176:177], v[118:119], v[118:119], v[176:177]
    v_pk_fma_f32 v[160:161], v[128:129], v[128:129], s[68:69]
    v_pk_fma_f32 v[162:163], v[130:131], v[130:131], s[68:69]
    v_pk_fma_f32 v[164:165], v[132:133], v[132:133], s[68:69]
    v_pk_fma_f32 v[166:167], v[134:135], v[134:135], s[68:69]
    v_pk_mul_f32 v[160:161], v[160:161], v[128:129] neg_lo:[1,0] neg_hi:[1,0]
    v_pk_mul_f32 v[162:163], v[162:163], v[130:131] neg_lo:[1,0] neg_hi:[1,0]
    v_pk_mul_f32 v[164:165], v[164:165], v[132:133] neg_lo:[1,0] neg_hi:[1,0]
    v_pk_mul_f32 v[166:167], v[166:167], v[134:135] neg_lo:[1,0] neg_hi:[1,0]
    v_cvt_pk_bf16_f32 v184, v112, v113
    v_cvt_pk_bf16_f32 v185, v114, v115
    v_cvt_pk_bf16_f32 v186, v116, v117
    v_cvt_pk_bf16_f32 v187, v118, v119
    v_add_u32_e64 v4, s89, v10
    v_mfma_f32_32x32x16_bf16 v[240:255], v[200:203], v[96:99], v[240:255]
    v_rcp_f32 v168, v168
    v_rcp_f32_e64 v169, v169
    s_waitcnt lgkmcnt(15)
    v_mfma_f32_32x32x16_bf16 v[240:255], v[204:207], v[100:103], v[240:255]
    v_rcp_f32 v170, v170
    v_rcp_f32_e64 v171, v171
    s_waitcnt lgkmcnt(14)
    v_mfma_f32_32x32x16_bf16 v[144:159], v[64:67], v[88:91], 0
    ds_read_b64_tr_b16 v[88:89], v4 offset:0
    ds_read_b64_tr_b16 v[90:91], v4 offset:256
    v_rcp_f32 v172, v172
    v_rcp_f32_e64 v173, v173
    s_waitcnt lgkmcnt(15)
    v_mfma_f32_32x32x16_bf16 v[144:159], v[68:71], v[92:95], v[144:159]
    ds_read_b64_tr_b16 v[92:93], v4 offset:1024
    ds_read_b64_tr_b16 v[94:95], v4 offset:1280
    v_rcp_f32 v174, v174
    v_rcp_f32_e64 v175, v175
    s_waitcnt lgkmcnt(15)
    v_mfma_f32_32x32x16_bf16 v[144:159], v[72:75], v[96:99], v[144:159]
    ds_read_b64_tr_b16 v[96:97], v4 offset:2048
    ds_read_b64_tr_b16 v[98:99], v4 offset:2304
    v_exp_f32 v160, v160
    v_exp_f32 v161, v161
    v_exp_f32 v162, v162
    v_exp_f32 v163, v163
    v_exp_f32 v164, v164
    v_exp_f32 v165, v165
    v_exp_f32 v166, v166
    v_exp_f32 v167, v167
    v_pk_mul_f32 v[120:121], v[120:121], v[168:169]
    v_pk_mul_f32 v[122:123], v[122:123], v[170:171]
    v_pk_mul_f32 v[124:125], v[124:125], v[172:173]
    v_pk_mul_f32 v[126:127], v[126:127], v[174:175]
    v_pk_add_f32 v[160:161], v[160:161], 1.0 op_sel_hi:[1,0]
    v_pk_add_f32 v[162:163], v[162:163], 1.0 op_sel_hi:[1,0]
    v_pk_add_f32 v[164:165], v[164:165], 1.0 op_sel_hi:[1,0]
    v_pk_add_f32 v[166:167], v[166:167], 1.0 op_sel_hi:[1,0]
    v_pk_fma_f32 v[176:177], v[120:121], v[120:121], v[176:177]
    v_pk_fma_f32 v[176:177], v[122:123], v[122:123], v[176:177]
    v_pk_fma_f32 v[176:177], v[124:125], v[124:125], v[176:177]
    v_pk_fma_f32 v[176:177], v[126:127], v[126:127], v[176:177]
    v_pk_fma_f32 v[168:169], v[136:137], v[136:137], s[68:69]
    v_pk_fma_f32 v[170:171], v[138:139], v[138:139], s[68:69]
    v_pk_fma_f32 v[172:173], v[140:141], v[140:141], s[68:69]
    v_pk_fma_f32 v[174:175], v[142:143], v[142:143], s[68:69]
    v_pk_mul_f32 v[168:169], v[168:169], v[136:137] neg_lo:[1,0] neg_hi:[1,0]
    v_pk_mul_f32 v[170:171], v[170:171], v[138:139] neg_lo:[1,0] neg_hi:[1,0]
    v_pk_mul_f32 v[172:173], v[172:173], v[140:141] neg_lo:[1,0] neg_hi:[1,0]
    v_pk_mul_f32 v[174:175], v[174:175], v[142:143] neg_lo:[1,0] neg_hi:[1,0]
    v_cvt_pk_bf16_f32 v188, v120, v121
    v_cvt_pk_bf16_f32 v189, v122, v123
    v_cvt_pk_bf16_f32 v190, v124, v125
    v_cvt_pk_bf16_f32 v191, v126, v127
    s_waitcnt lgkmcnt(14)
    v_mfma_f32_32x32x16_bf16 v[240:255], v[208:211], v[104:107], v[240:255]
    v_rcp_f32 v160, v160
    v_rcp_f32 v161, v161
    s_waitcnt lgkmcnt(13)
    v_mfma_f32_32x32x16_bf16 v[240:255], v[212:215], v[108:111], v[240:255]
    v_rcp_f32 v162, v162
    v_rcp_f32 v163, v163
    v_mfma_f32_32x32x16_bf16 v[144:159], v[76:79], v[100:103], v[144:159]
    ds_read_b64_tr_b16 v[100:101], v4 offset:3072
    ds_read_b64_tr_b16 v[102:103], v4 offset:3328
    v_rcp_f32 v164, v164
    v_rcp_f32 v165, v165
    v_mfma_f32_32x32x16_bf16 v[144:159], v[80:83], v[104:107], v[144:159]
    ds_read_b64_tr_b16 v[104:105], v4 offset:4096
    ds_read_b64_tr_b16 v[106:107], v4 offset:4352
    v_rcp_f32 v166, v166
    v_rcp_f32 v167, v167
    v_mfma_f32_32x32x16_bf16 v[144:159], v[84:87], v[108:111], v[144:159]
    ds_read_b64_tr_b16 v[108:109], v4 offset:5120
    ds_read_b64_tr_b16 v[110:111], v4 offset:5376
    v_exp_f32 v168, v168
    v_exp_f32 v169, v169
    v_exp_f32 v170, v170
    v_exp_f32 v171, v171
    v_exp_f32 v172, v172
    v_exp_f32 v173, v173
    v_exp_f32 v174, v174
    v_exp_f32 v175, v175
    v_pk_mul_f32 v[128:129], v[128:129], v[160:161]
    v_pk_mul_f32 v[130:131], v[130:131], v[162:163]
    v_pk_mul_f32 v[132:133], v[132:133], v[164:165]
    v_pk_mul_f32 v[134:135], v[134:135], v[166:167]
    v_pk_add_f32 v[168:169], v[168:169], 1.0 op_sel_hi:[1,0]
    v_pk_add_f32 v[170:171], v[170:171], 1.0 op_sel_hi:[1,0]
    v_pk_add_f32 v[172:173], v[172:173], 1.0 op_sel_hi:[1,0]
    v_pk_add_f32 v[174:175], v[174:175], 1.0 op_sel_hi:[1,0]
    v_pk_fma_f32 v[176:177], v[128:129], v[128:129], v[176:177]
    v_pk_fma_f32 v[176:177], v[130:131], v[130:131], v[176:177]
    v_pk_fma_f32 v[176:177], v[132:133], v[132:133], v[176:177]
    v_pk_fma_f32 v[176:177], v[134:135], v[134:135], v[176:177]
    v_pk_fma_f32 v[160:161], v[144:145], v[144:145], s[68:69]
    v_pk_fma_f32 v[162:163], v[146:147], v[146:147], s[68:69]
    v_pk_fma_f32 v[164:165], v[148:149], v[148:149], s[68:69]
    v_pk_fma_f32 v[166:167], v[150:151], v[150:151], s[68:69]
    v_pk_mul_f32 v[160:161], v[160:161], v[144:145] neg_lo:[1,0] neg_hi:[1,0]
    v_pk_mul_f32 v[162:163], v[162:163], v[146:147] neg_lo:[1,0] neg_hi:[1,0]
    v_pk_mul_f32 v[164:165], v[164:165], v[148:149] neg_lo:[1,0] neg_hi:[1,0]
    v_pk_mul_f32 v[166:167], v[166:167], v[150:151] neg_lo:[1,0] neg_hi:[1,0]
    v_cvt_pk_bf16_f32 v192, v128, v129
    v_cvt_pk_bf16_f32 v193, v130, v131
    v_cvt_pk_bf16_f32 v194, v132, v133
    v_cvt_pk_bf16_f32 v195, v134, v135
    s_waitcnt lgkmcnt(10)
    v_mfma_f32_32x32x16_bf16 v[240:255], v[216:219], v[88:91], v[240:255]
    v_rcp_f32 v168, v168
    v_rcp_f32 v169, v169
    v_rcp_f32 v170, v170
    v_mfma_f32_32x32x16_bf16 v[112:127], v[16:19], v[88:91], 0
    v_rcp_f32 v171, v171
    v_rcp_f32 v172, v172
    v_rcp_f32 v173, v173
    s_waitcnt lgkmcnt(8)
    v_mfma_f32_32x32x16_bf16 v[112:127], v[20:23], v[92:95], v[112:127]
    v_rcp_f32 v174, v174
    v_rcp_f32 v175, v175
    v_exp_f32 v160, v160
    s_waitcnt lgkmcnt(6)
    v_mfma_f32_32x32x16_bf16 v[112:127], v[24:27], v[96:99], v[112:127]
    v_exp_f32 v161, v161
    v_exp_f32 v162, v162
    v_exp_f32 v163, v163
    v_exp_f32 v164, v164
    v_exp_f32 v165, v165
    v_exp_f32 v166, v166
    v_exp_f32_e64 v167, v167
    v_pk_mul_f32 v[136:137], v[136:137], v[168:169]
    v_pk_mul_f32 v[138:139], v[138:139], v[170:171]
    v_pk_mul_f32 v[140:141], v[140:141], v[172:173]
    v_pk_mul_f32 v[142:143], v[142:143], v[174:175]
    v_pk_add_f32 v[160:161], v[160:161], 1.0 op_sel_hi:[1,0]
    v_pk_add_f32 v[162:163], v[162:163], 1.0 op_sel_hi:[1,0]
    v_pk_add_f32 v[164:165], v[164:165], 1.0 op_sel_hi:[1,0]
    v_pk_add_f32 v[166:167], v[166:167], 1.0 op_sel_hi:[1,0]
    v_pk_fma_f32 v[176:177], v[136:137], v[136:137], v[176:177]
    v_pk_fma_f32 v[176:177], v[138:139], v[138:139], v[176:177]
    v_pk_fma_f32 v[176:177], v[140:141], v[140:141], v[176:177]
    v_pk_fma_f32 v[176:177], v[142:143], v[142:143], v[176:177]
    v_pk_fma_f32 v[168:169], v[152:153], v[152:153], s[68:69]
    v_pk_fma_f32 v[170:171], v[154:155], v[154:155], s[68:69]
    v_pk_fma_f32 v[172:173], v[156:157], v[156:157], s[68:69]
    v_pk_fma_f32 v[174:175], v[158:159], v[158:159], s[68:69]
    v_pk_mul_f32 v[168:169], v[168:169], v[152:153] neg_lo:[1,0] neg_hi:[1,0]
    v_pk_mul_f32 v[170:171], v[170:171], v[154:155] neg_lo:[1,0] neg_hi:[1,0]
    v_pk_mul_f32 v[172:173], v[172:173], v[156:157] neg_lo:[1,0] neg_hi:[1,0]
    v_pk_mul_f32 v[174:175], v[174:175], v[158:159] neg_lo:[1,0] neg_hi:[1,0]
    v_cvt_pk_bf16_f32 v196, v136, v137
    v_cvt_pk_bf16_f32 v197, v138, v139
    v_cvt_pk_bf16_f32 v198, v140, v141
    v_cvt_pk_bf16_f32 v199, v142, v143
    v_mfma_f32_32x32x16_bf16 v[240:255], v[220:223], v[92:95], v[240:255]
    v_rcp_f32 v160, v160
    v_rcp_f32 v161, v161
    v_rcp_f32 v162, v162
    s_waitcnt lgkmcnt(4)
    v_mfma_f32_32x32x16_bf16 v[112:127], v[28:31], v[100:103], v[112:127]
    v_rcp_f32 v163, v163
    v_rcp_f32 v164, v164
    v_rcp_f32 v165, v165
    s_waitcnt lgkmcnt(2)
    v_mfma_f32_32x32x16_bf16 v[112:127], v[32:35], v[104:107], v[112:127]
    v_rcp_f32 v166, v166
    v_rcp_f32 v167, v167
    v_exp_f32 v168, v168
    s_waitcnt lgkmcnt(0)
    v_mfma_f32_32x32x16_bf16 v[112:127], v[36:39], v[108:111], v[112:127]
    v_exp_f32 v169, v169
    v_exp_f32 v170, v170
    v_exp_f32 v171, v171
    v_exp_f32 v172, v172
    v_exp_f32 v173, v173
    v_exp_f32 v174, v174
    v_exp_f32_e64 v175, v175
    v_pk_mul_f32 v[144:145], v[144:145], v[160:161]
    v_pk_mul_f32 v[146:147], v[146:147], v[162:163]
    v_pk_mul_f32 v[148:149], v[148:149], v[164:165]
    v_pk_mul_f32 v[150:151], v[150:151], v[166:167]
    v_pk_add_f32 v[168:169], v[168:169], 1.0 op_sel_hi:[1,0]
    v_pk_add_f32 v[170:171], v[170:171], 1.0 op_sel_hi:[1,0]
    v_pk_add_f32 v[172:173], v[172:173], 1.0 op_sel_hi:[1,0]
    v_pk_add_f32 v[174:175], v[174:175], 1.0 op_sel_hi:[1,0]
    v_pk_fma_f32 v[176:177], v[144:145], v[144:145], v[176:177]
    v_pk_fma_f32 v[176:177], v[146:147], v[146:147], v[176:177]
    v_pk_fma_f32 v[176:177], v[148:149], v[148:149], v[176:177]
    v_pk_fma_f32 v[176:177], v[150:151], v[150:151], v[176:177]
    v_pk_fma_f32 v[160:161], v[112:113], v[112:113], s[68:69]
    v_pk_fma_f32 v[162:163], v[114:115], v[114:115], s[68:69]
    v_pk_fma_f32 v[164:165], v[116:117], v[116:117], s[68:69]
    v_pk_fma_f32 v[166:167], v[118:119], v[118:119], s[68:69]
    v_pk_mul_f32 v[160:161], v[160:161], v[112:113] neg_lo:[1,0] neg_hi:[1,0]
    v_pk_mul_f32 v[162:163], v[162:163], v[114:115] neg_lo:[1,0] neg_hi:[1,0]
    v_pk_mul_f32 v[164:165], v[164:165], v[116:117] neg_lo:[1,0] neg_hi:[1,0]
    v_pk_mul_f32 v[166:167], v[166:167], v[118:119] neg_lo:[1,0] neg_hi:[1,0]
    v_cvt_pk_bf16_f32 v200, v144, v145
    v_cvt_pk_bf16_f32 v201, v146, v147
    v_cvt_pk_bf16_f32 v202, v148, v149
    v_cvt_pk_bf16_f32 v203, v150, v151
    v_mfma_f32_32x32x16_bf16 v[240:255], v[224:227], v[96:99], v[240:255]
    v_rcp_f32 v168, v168
    v_rcp_f32 v169, v169
    v_rcp_f32_e64 v170, v170
    v_mfma_f32_32x32x16_bf16 v[128:143], v[40:43], v[88:91], 0
    v_rcp_f32 v171, v171
    v_rcp_f32 v172, v172
    v_rcp_f32_e64 v173, v173
    v_mfma_f32_32x32x16_bf16 v[128:143], v[44:47], v[92:95], v[128:143]
    v_rcp_f32 v174, v174
    v_rcp_f32 v175, v175
    v_exp_f32_e64 v160, v160
    v_mfma_f32_32x32x16_bf16 v[128:143], v[48:51], v[96:99], v[128:143]
    v_exp_f32 v161, v161
    v_exp_f32 v162, v162
    v_exp_f32 v163, v163
    v_exp_f32 v164, v164
    v_exp_f32 v165, v165
    v_exp_f32 v166, v166
    v_exp_f32_e64 v167, v167
    v_pk_mul_f32 v[152:153], v[152:153], v[168:169]
    v_pk_mul_f32 v[154:155], v[154:155], v[170:171]
    v_pk_mul_f32 v[156:157], v[156:157], v[172:173]
    v_pk_mul_f32 v[158:159], v[158:159], v[174:175]
    v_pk_add_f32 v[160:161], v[160:161], 1.0 op_sel_hi:[1,0]
    v_pk_add_f32 v[162:163], v[162:163], 1.0 op_sel_hi:[1,0]
    v_pk_add_f32 v[164:165], v[164:165], 1.0 op_sel_hi:[1,0]
    v_pk_add_f32 v[166:167], v[166:167], 1.0 op_sel_hi:[1,0]
    v_pk_fma_f32 v[176:177], v[152:153], v[152:153], v[176:177]
    v_pk_fma_f32 v[176:177], v[154:155], v[154:155], v[176:177]
    v_pk_fma_f32 v[176:177], v[156:157], v[156:157], v[176:177]
    v_pk_fma_f32 v[176:177], v[158:159], v[158:159], v[176:177]
    v_pk_fma_f32 v[168:169], v[120:121], v[120:121], s[68:69]
    v_pk_fma_f32 v[170:171], v[122:123], v[122:123], s[68:69]
    v_pk_fma_f32 v[172:173], v[124:125], v[124:125], s[68:69]
    v_pk_fma_f32 v[174:175], v[126:127], v[126:127], s[68:69]
    v_pk_mul_f32 v[168:169], v[168:169], v[120:121] neg_lo:[1,0] neg_hi:[1,0]
    v_pk_mul_f32 v[170:171], v[170:171], v[122:123] neg_lo:[1,0] neg_hi:[1,0]
    v_pk_mul_f32 v[172:173], v[172:173], v[124:125] neg_lo:[1,0] neg_hi:[1,0]
    v_pk_mul_f32 v[174:175], v[174:175], v[126:127] neg_lo:[1,0] neg_hi:[1,0]
    v_cvt_pk_bf16_f32 v204, v152, v153
    v_cvt_pk_bf16_f32 v205, v154, v155
    v_cvt_pk_bf16_f32 v206, v156, v157
    v_cvt_pk_bf16_f32 v207, v158, v159
    v_mfma_f32_32x32x16_bf16 v[240:255], v[228:231], v[100:103], v[240:255]
    v_add_f32 v180, v176, v177
    v_add_u32 v181, s91, v12
    v_rcp_f32_e64 v160, v160
    v_mfma_f32_32x32x16_bf16 v[128:143], v[52:55], v[100:103], v[128:143]
    v_rcp_f32 v161, v161
    v_rcp_f32 v162, v162
    v_rcp_f32_e64 v163, v163
    v_mfma_f32_32x32x16_bf16 v[128:143], v[56:59], v[104:107], v[128:143]
    v_rcp_f32 v164, v164
    v_rcp_f32 v165, v165
    v_rcp_f32_e64 v166, v166
    v_mfma_f32_32x32x16_bf16 v[128:143], v[60:63], v[108:111], v[128:143]
    v_rcp_f32 v167, v167
    v_exp_f32 v168, v168
    v_exp_f32 v169, v169
    v_exp_f32 v170, v170
    v_exp_f32 v171, v171
    v_exp_f32 v172, v172
    v_exp_f32 v173, v173
    v_exp_f32 v174, v174
    v_exp_f32_e64 v175, v175
    v_pk_mul_f32 v[112:113], v[112:113], v[160:161]
    v_pk_mul_f32 v[114:115], v[114:115], v[162:163]
    v_pk_mul_f32 v[116:117], v[116:117], v[164:165]
    v_pk_mul_f32 v[118:119], v[118:119], v[166:167]
    v_pk_add_f32 v[168:169], v[168:169], 1.0 op_sel_hi:[1,0]
    v_pk_add_f32 v[170:171], v[170:171], 1.0 op_sel_hi:[1,0]
    v_pk_add_f32 v[172:173], v[172:173], 1.0 op_sel_hi:[1,0]
    v_pk_add_f32 v[174:175], v[174:175], 1.0 op_sel_hi:[1,0]
    v_pk_mul_f32 v[178:179], v[112:113], v[112:113]
    v_pk_fma_f32 v[178:179], v[114:115], v[114:115], v[178:179]
    v_pk_fma_f32 v[178:179], v[116:117], v[116:117], v[178:179]
    v_pk_fma_f32 v[178:179], v[118:119], v[118:119], v[178:179]
    v_pk_fma_f32 v[160:161], v[128:129], v[128:129], s[68:69]
    v_pk_fma_f32 v[162:163], v[130:131], v[130:131], s[68:69]
    v_pk_fma_f32 v[164:165], v[132:133], v[132:133], s[68:69]
    v_pk_fma_f32 v[166:167], v[134:135], v[134:135], s[68:69]
    v_pk_mul_f32 v[160:161], v[160:161], v[128:129] neg_lo:[1,0] neg_hi:[1,0]
    v_pk_mul_f32 v[162:163], v[162:163], v[130:131] neg_lo:[1,0] neg_hi:[1,0]
    v_pk_mul_f32 v[164:165], v[164:165], v[132:133] neg_lo:[1,0] neg_hi:[1,0]
    v_pk_mul_f32 v[166:167], v[166:167], v[134:135] neg_lo:[1,0] neg_hi:[1,0]
    v_cvt_pk_bf16_f32 v208, v112, v113
    v_cvt_pk_bf16_f32 v209, v114, v115
    v_cvt_pk_bf16_f32 v210, v116, v117
    v_cvt_pk_bf16_f32 v211, v118, v119
    s_cmp_lg_u32 s60, 3
    s_cbranch_scc1 L_sk22
    s_waitcnt vmcnt(0)
    s_lshr_b32 s71, s81, 5
    s_lshl_b32 s72, s80, 3
    s_add_u32 s71, s71, s72
    s_lshl_b32 s71, s71, 2
    s_lshl_b32 s72, 1, s81
    v_mov_b32 v182, s71
    v_mov_b32_e64 v183, s72
    s_mov_b64 exec, 1
    buffer_atomic_or v183, v182, s[48:51], 0 offen
    s_mov_b64 exec, -1
L_sk22:
    v_add_u32 v4, s90, v10
    v_mfma_f32_32x32x16_bf16 v[240:255], v[232:235], v[104:107], v[240:255]
    ds_write_b32 v181, v180
    v_rcp_f32 v168, v168
    v_rcp_f32 v169, v169
    v_rcp_f32_e64 v170, v170
    v_mfma_f32_32x32x16_bf16 v[144:159], v[64:67], v[88:91], 0
    ds_read_b64_tr_b16 v[88:89], v4 offset:0
    ds_read_b64_tr_b16 v[90:91], v4 offset:256
    v_rcp_f32 v171, v171
    v_rcp_f32 v172, v172
    v_rcp_f32_e64 v173, v173
    v_mfma_f32_32x32x16_bf16 v[144:159], v[68:71], v[92:95], v[144:159]
    ds_read_b64_tr_b16 v[92:93], v4 offset:1024
    ds_read_b64_tr_b16 v[94:95], v4 offset:1280
    v_rcp_f32 v174, v174
    v_rcp_f32 v175, v175
    v_exp_f32_e64 v160, v160
    v_mfma_f32_32x32x16_bf16 v[144:159], v[72:75], v[96:99], v[144:159]
    ds_read_b64_tr_b16 v[96:97], v4 offset:2048
    ds_read_b64_tr_b16 v[98:99], v4 offset:2304
    v_exp_f32 v161, v161
    v_exp_f32 v162, v162
    v_exp_f32 v163, v163
    v_exp_f32 v164, v164
    v_exp_f32 v165, v165
    v_exp_f32 v166, v166
    v_exp_f32_e64 v167, v167
    v_pk_mul_f32 v[120:121], v[120:121], v[168:169]
    v_pk_mul_f32 v[122:123], v[122:123], v[170:171]
    v_pk_mul_f32 v[124:125], v[124:125], v[172:173]
    v_pk_mul_f32 v[126:127], v[126:127], v[174:175]
    v_pk_add_f32 v[160:161], v[160:161], 1.0 op_sel_hi:[1,0]
    v_pk_add_f32 v[162:163], v[162:163], 1.0 op_sel_hi:[1,0]
    v_pk_add_f32 v[164:165], v[164:165], 1.0 op_sel_hi:[1,0]
    v_pk_add_f32 v[166:167], v[166:167], 1.0 op_sel_hi:[1,0]
    v_pk_fma_f32 v[178:179], v[120:121], v[120:121], v[178:179]
    v_pk_fma_f32 v[178:179], v[122:123], v[122:123], v[178:179]
    v_pk_fma_f32 v[178:179], v[124:125], v[124:125], v[178:179]
    v_pk_fma_f32 v[178:179], v[126:127], v[126:127], v[178:179]
    v_pk_fma_f32 v[168:169], v[136:137], v[136:137], s[68:69]
    v_pk_fma_f32 v[170:171], v[138:139], v[138:139], s[68:69]
    v_pk_fma_f32 v[172:173], v[140:141], v[140:141], s[68:69]
    v_pk_fma_f32 v[174:175], v[142:143], v[142:143], s[68:69]
    v_pk_mul_f32 v[168:169], v[168:169], v[136:137] neg_lo:[1,0] neg_hi:[1,0]
    v_pk_mul_f32 v[170:171], v[170:171], v[138:139] neg_lo:[1,0] neg_hi:[1,0]
    v_pk_mul_f32 v[172:173], v[172:173], v[140:141] neg_lo:[1,0] neg_hi:[1,0]
    v_pk_mul_f32 v[174:175], v[174:175], v[142:143] neg_lo:[1,0] neg_hi:[1,0]
    v_cvt_pk_bf16_f32 v212, v120, v121
    v_cvt_pk_bf16_f32 v213, v122, v123
    v_cvt_pk_bf16_f32 v214, v124, v125
    v_cvt_pk_bf16_f32 v215, v126, v127
    v_mfma_f32_32x32x16_bf16 v[240:255], v[236:239], v[108:111], v[240:255]
    v_rcp_f32 v160, v160
    v_rcp_f32 v161, v161
    v_rcp_f32_e64 v162, v162
    v_mfma_f32_32x32x16_bf16 v[144:159], v[76:79], v[100:103], v[144:159]
    ds_read_b64_tr_b16 v[100:101], v4 offset:3072
    ds_read_b64_tr_b16 v[102:103], v4 offset:3328
    v_rcp_f32 v163, v163
    v_rcp_f32 v164, v164
    v_rcp_f32_e64 v165, v165
    v_mfma_f32_32x32x16_bf16 v[144:159], v[80:83], v[104:107], v[144:159]
    ds_read_b64_tr_b16 v[104:105], v4 offset:4096
    ds_read_b64_tr_b16 v[106:107], v4 offset:4352
    v_rcp_f32 v166, v166
    v_rcp_f32 v167, v167
    v_exp_f32_e64 v168, v168
    v_mfma_f32_32x32x16_bf16 v[144:159], v[84:87], v[108:111], v[144:159]
    ds_read_b64_tr_b16 v[108:109], v4 offset:5120
    ds_read_b64_tr_b16 v[110:111], v4 offset:5376
    v_exp_f32 v169, v169
    v_exp_f32 v170, v170
    v_exp_f32 v171, v171
    v_exp_f32 v172, v172
    v_exp_f32 v173, v173
    v_exp_f32 v174, v174
    v_exp_f32_e64 v175, v175
    v_pk_mul_f32 v[128:129], v[128:129], v[160:161]
    v_pk_mul_f32 v[130:131], v[130:131], v[162:163]
    v_pk_mul_f32 v[132:133], v[132:133], v[164:165]
    v_pk_mul_f32 v[134:135], v[134:135], v[166:167]
    v_pk_add_f32 v[168:169], v[168:169], 1.0 op_sel_hi:[1,0]
    v_pk_add_f32 v[170:171], v[170:171], 1.0 op_sel_hi:[1,0]
    v_pk_add_f32 v[172:173], v[172:173], 1.0 op_sel_hi:[1,0]
    v_pk_add_f32 v[174:175], v[174:175], 1.0 op_sel_hi:[1,0]
    v_pk_fma_f32 v[178:179], v[128:129], v[128:129], v[178:179]
    v_pk_fma_f32 v[178:179], v[130:131], v[130:131], v[178:179]
    v_pk_fma_f32 v[178:179], v[132:133], v[132:133], v[178:179]
    v_pk_fma_f32 v[178:179], v[134:135], v[134:135], v[178:179]
    v_pk_fma_f32 v[160:161], v[240:241], v[240:241], s[68:69]
    v_pk_fma_f32 v[162:163], v[242:243], v[242:243], s[68:69]
    v_pk_mul_f32 v[160:161], v[160:161], v[240:241] neg_lo:[1,0] neg_hi:[1,0]
    v_pk_mul_f32 v[162:163], v[162:163], v[242:243] neg_lo:[1,0] neg_hi:[1,0]
    v_cvt_pk_bf16_f32 v216, v128, v129
    v_cvt_pk_bf16_f32 v217, v130, v131
    v_cvt_pk_bf16_f32 v218, v132, v133
    v_cvt_pk_bf16_f32 v219, v134, v135
    s_waitcnt lgkmcnt(10)
    v_mfma_f32_32x32x16_bf16 v[112:127], v[16:19], v[88:91], 0
    v_rcp_f32 v168, v168
    v_rcp_f32 v169, v169
    v_rcp_f32_e64 v170, v170
    s_waitcnt lgkmcnt(8)
    v_mfma_f32_32x32x16_bf16 v[112:127], v[20:23], v[92:95], v[112:127]
    v_rcp_f32 v171, v171
    v_rcp_f32 v172, v172
    v_rcp_f32 v173, v173
    s_waitcnt lgkmcnt(6)
    v_mfma_f32_32x32x16_bf16 v[112:127], v[24:27], v[96:99], v[112:127]
    v_rcp_f32 v174, v174
    v_rcp_f32 v175, v175
    v_exp_f32 v160, v160
    v_exp_f32 v161, v161
    v_exp_f32 v162, v162
    v_exp_f32 v163, v163
    v_pk_mul_f32 v[136:137], v[136:137], v[168:169]
    v_pk_mul_f32 v[138:139], v[138:139], v[170:171]
    v_pk_mul_f32 v[140:141], v[140:141], v[172:173]
    v_pk_mul_f32 v[142:143], v[142:143], v[174:175]
    v_pk_add_f32 v[160:161], v[160:161], 1.0 op_sel_hi:[1,0]
    v_pk_add_f32 v[162:163], v[162:163], 1.0 op_sel_hi:[1,0]
    v_pk_fma_f32 v[178:179], v[136:137], v[136:137], v[178:179]
    v_pk_fma_f32 v[178:179], v[138:139], v[138:139], v[178:179]
    v_pk_fma_f32 v[178:179], v[140:141], v[140:141], v[178:179]
    v_pk_fma_f32 v[178:179], v[142:143], v[142:143], v[178:179]
    v_pk_fma_f32 v[168:169], v[144:145], v[144:145], s[68:69]
    v_pk_fma_f32 v[170:171], v[146:147], v[146:147], s[68:69]
    v_pk_fma_f32 v[172:173], v[148:149], v[148:149], s[68:69]
    v_pk_fma_f32 v[174:175], v[150:151], v[150:151], s[68:69]
    v_pk_mul_f32 v[168:169], v[168:169], v[144:145] neg_lo:[1,0] neg_hi:[1,0]
    v_pk_mul_f32 v[170:171], v[170:171], v[146:147] neg_lo:[1,0] neg_hi:[1,0]
    v_pk_mul_f32 v[172:173], v[172:173], v[148:149] neg_lo:[1,0] neg_hi:[1,0]
    v_pk_mul_f32 v[174:175], v[174:175], v[150:151] neg_lo:[1,0] neg_hi:[1,0]
    v_cvt_pk_bf16_f32 v220, v136, v137
    v_cvt_pk_bf16_f32 v221, v138, v139
    v_cvt_pk_bf16_f32 v222, v140, v141
    v_cvt_pk_bf16_f32 v223, v142, v143
    v_rcp_f32 v160, v160
    v_rcp_f32 v161, v161
    v_rcp_f32 v162, v162
    v_rcp_f32 v163, v163
    v_exp_f32 v168, v168
    v_exp_f32 v169, v169
    v_exp_f32 v170, v170
    v_exp_f32 v171, v171
    v_exp_f32 v172, v172
    v_exp_f32 v173, v173
    v_exp_f32 v174, v174
    v_exp_f32 v175, v175
    v_pk_mul_f32 v[240:241], v[240:241], v[160:161]
    v_pk_mul_f32 v[242:243], v[242:243], v[162:163]
    v_pk_add_f32 v[168:169], v[168:169], 1.0 op_sel_hi:[1,0]
    v_pk_add_f32 v[170:171], v[170:171], 1.0 op_sel_hi:[1,0]
    v_pk_add_f32 v[172:173], v[172:173], 1.0 op_sel_hi:[1,0]
    v_pk_add_f32 v[174:175], v[174:175], 1.0 op_sel_hi:[1,0]
    v_pk_mul_f32 v[244:245], v[240:241], v[240:241]
    v_pk_fma_f32 v[244:245], v[242:243], v[242:243], v[244:245]
    v_pk_fma_f32 v[160:161], v[152:153], v[152:153], s[68:69]
    v_pk_fma_f32 v[162:163], v[154:155], v[154:155], s[68:69]
    v_pk_fma_f32 v[164:165], v[156:157], v[156:157], s[68:69]
    v_pk_fma_f32 v[166:167], v[158:159], v[158:159], s[68:69]
    v_pk_mul_f32 v[160:161], v[160:161], v[152:153] neg_lo:[1,0] neg_hi:[1,0]
    v_pk_mul_f32 v[162:163], v[162:163], v[154:155] neg_lo:[1,0] neg_hi:[1,0]
    v_pk_mul_f32 v[164:165], v[164:165], v[156:157] neg_lo:[1,0] neg_hi:[1,0]
    v_pk_mul_f32 v[166:167], v[166:167], v[158:159] neg_lo:[1,0] neg_hi:[1,0]
    v_cvt_pk_bf16_f32 v182, v240, v241
    v_cvt_pk_bf16_f32 v183, v242, v243
    s_waitcnt lgkmcnt(4)
    v_mfma_f32_32x32x16_bf16 v[112:127], v[28:31], v[100:103], v[112:127]
    v_add_f32 v244, v244, v245
    v_rcp_f32 v168, v168
    v_rcp_f32_e64 v169, v169
    s_waitcnt lgkmcnt(2)
    v_mfma_f32_32x32x16_bf16 v[112:127], v[32:35], v[104:107], v[112:127]
    v_rcp_f32 v170, v170
    v_rcp_f32 v171, v171
    v_rcp_f32 v172, v172
    s_waitcnt lgkmcnt(0)
    v_mfma_f32_32x32x16_bf16 v[112:127], v[36:39], v[108:111], v[112:127]
    v_rcp_f32 v173, v173
    v_rcp_f32 v174, v174
    v_rcp_f32 v175, v175
    v_exp_f32 v160, v160
    v_exp_f32 v161, v161
    v_exp_f32 v162, v162
    v_exp_f32 v163, v163
    v_exp_f32 v164, v164
    v_exp_f32 v165, v165
    v_exp_f32 v166, v166
    v_exp_f32_e64 v167, v167
    v_pk_mul_f32 v[144:145], v[144:145], v[168:169]
    v_pk_mul_f32 v[146:147], v[146:147], v[170:171]
    v_pk_mul_f32 v[148:149], v[148:149], v[172:173]
    v_pk_mul_f32 v[150:151], v[150:151], v[174:175]
    v_pk_add_f32 v[160:161], v[160:161], 1.0 op_sel_hi:[1,0]
    v_pk_add_f32 v[162:163], v[162:163], 1.0 op_sel_hi:[1,0]
    v_pk_add_f32 v[164:165], v[164:165], 1.0 op_sel_hi:[1,0]
    v_pk_add_f32 v[166:167], v[166:167], 1.0 op_sel_hi:[1,0]
    v_pk_fma_f32 v[178:179], v[144:145], v[144:145], v[178:179]
    v_pk_fma_f32 v[178:179], v[146:147], v[146:147], v[178:179]
    v_pk_fma_f32 v[178:179], v[148:149], v[148:149], v[178:179]
    v_pk_fma_f32 v[178:179], v[150:151], v[150:151], v[178:179]
    v_pk_fma_f32 v[168:169], v[112:113], v[112:113], s[68:69]
    v_pk_fma_f32 v[170:171], v[114:115], v[114:115], s[68:69]
    v_pk_fma_f32 v[172:173], v[116:117], v[116:117], s[68:69]
    v_pk_fma_f32 v[174:175], v[118:119], v[118:119], s[68:69]
    v_pk_mul_f32 v[168:169], v[168:169], v[112:113] neg_lo:[1,0] neg_hi:[1,0]
    v_pk_mul_f32 v[170:171], v[170:171], v[114:115] neg_lo:[1,0] neg_hi:[1,0]
    v_pk_mul_f32 v[172:173], v[172:173], v[116:117] neg_lo:[1,0] neg_hi:[1,0]
    v_pk_mul_f32 v[174:175], v[174:175], v[118:119] neg_lo:[1,0] neg_hi:[1,0]
    v_cvt_pk_bf16_f32 v224, v144, v145
    v_cvt_pk_bf16_f32 v225, v146, v147
    v_cvt_pk_bf16_f32 v226, v148, v149
    v_cvt_pk_bf16_f32 v227, v150, v151
    v_mfma_f32_32x32x16_bf16 v[128:143], v[40:43], v[88:91], 0
    ds_write_b32 v11, v244
    v_rcp_f32 v160, v160
    v_rcp_f32 v161, v161
    v_rcp_f32_e64 v162, v162
    v_mfma_f32_32x32x16_bf16 v[128:143], v[44:47], v[92:95], v[128:143]
    ds_write_b64 v5, v[182:183]
    v_rcp_f32 v163, v163
    v_rcp_f32 v164, v164
    v_rcp_f32_e64 v165, v165
    v_mfma_f32_32x32x16_bf16 v[128:143], v[48:51], v[96:99], v[128:143]
    v_rcp_f32 v166, v166
    v_rcp_f32 v167, v167
    v_exp_f32 v168, v168
    v_exp_f32 v169, v169
    v_exp_f32 v170, v170
    v_exp_f32 v171, v171
    v_exp_f32 v172, v172
    v_exp_f32 v173, v173
    v_exp_f32 v174, v174
    v_exp_f32 v175, v175
    v_pk_mul_f32 v[152:153], v[152:153], v[160:161]
    v_pk_mul_f32 v[154:155], v[154:155], v[162:163]
    v_pk_mul_f32 v[156:157], v[156:157], v[164:165]
    v_pk_mul_f32 v[158:159], v[158:159], v[166:167]
    v_pk_add_f32 v[168:169], v[168:169], 1.0 op_sel_hi:[1,0]
    v_pk_add_f32 v[170:171], v[170:171], 1.0 op_sel_hi:[1,0]
    v_pk_add_f32 v[172:173], v[172:173], 1.0 op_sel_hi:[1,0]
    v_pk_add_f32 v[174:175], v[174:175], 1.0 op_sel_hi:[1,0]
    v_pk_fma_f32 v[178:179], v[152:153], v[152:153], v[178:179]
    v_pk_fma_f32 v[178:179], v[154:155], v[154:155], v[178:179]
    v_pk_fma_f32 v[178:179], v[156:157], v[156:157], v[178:179]
    v_pk_fma_f32 v[178:179], v[158:159], v[158:159], v[178:179]
    v_pk_fma_f32 v[160:161], v[120:121], v[120:121], s[68:69]
    v_pk_fma_f32 v[162:163], v[122:123], v[122:123], s[68:69]
    v_pk_fma_f32 v[164:165], v[124:125], v[124:125], s[68:69]
    v_pk_fma_f32 v[166:167], v[126:127], v[126:127], s[68:69]
    v_pk_mul_f32 v[160:161], v[160:161], v[120:121] neg_lo:[1,0] neg_hi:[1,0]
    v_pk_mul_f32 v[162:163], v[162:163], v[122:123] neg_lo:[1,0] neg_hi:[1,0]
    v_pk_mul_f32 v[164:165], v[164:165], v[124:125] neg_lo:[1,0] neg_hi:[1,0]
    v_pk_mul_f32 v[166:167], v[166:167], v[126:127] neg_lo:[1,0] neg_hi:[1,0]
    v_cvt_pk_bf16_f32 v228, v152, v153
    v_cvt_pk_bf16_f32 v229, v154, v155
    v_cvt_pk_bf16_f32 v230, v156, v157
    v_cvt_pk_bf16_f32 v231, v158, v159
    v_mfma_f32_32x32x16_bf16 v[128:143], v[52:55], v[100:103], v[128:143]
    v_add_f32 v180, v178, v179
    v_add_u32 v181, s92, v12
    v_rcp_f32_e64 v168, v168
    v_mfma_f32_32x32x16_bf16 v[128:143], v[56:59], v[104:107], v[128:143]
    v_rcp_f32 v169, v169
    v_rcp_f32 v170, v170
    v_rcp_f32_e64 v171, v171
    v_mfma_f32_32x32x16_bf16 v[128:143], v[60:63], v[108:111], v[128:143]
    v_rcp_f32 v172, v172
    v_rcp_f32 v173, v173
    v_rcp_f32 v174, v174
    v_rcp_f32 v175, v175
    v_exp_f32 v160, v160
    v_exp_f32 v161, v161
    v_exp_f32 v162, v162
    v_exp_f32 v163, v163
    v_exp_f32 v164, v164
    v_exp_f32 v165, v165
    v_exp_f32 v166, v166
    v_exp_f32 v167, v167
    v_pk_mul_f32 v[112:113], v[112:113], v[168:169]
    v_pk_mul_f32 v[114:115], v[114:115], v[170:171]
    v_pk_mul_f32 v[116:117], v[116:117], v[172:173]
    v_pk_mul_f32 v[118:119], v[118:119], v[174:175]
    v_pk_add_f32 v[160:161], v[160:161], 1.0 op_sel_hi:[1,0]
    v_pk_add_f32 v[162:163], v[162:163], 1.0 op_sel_hi:[1,0]
    v_pk_add_f32 v[164:165], v[164:165], 1.0 op_sel_hi:[1,0]
    v_pk_add_f32 v[166:167], v[166:167], 1.0 op_sel_hi:[1,0]
    v_pk_mul_f32 v[176:177], v[112:113], v[112:113]
    v_pk_fma_f32 v[176:177], v[114:115], v[114:115], v[176:177]
    v_pk_fma_f32 v[176:177], v[116:117], v[116:117], v[176:177]
    v_pk_fma_f32 v[176:177], v[118:119], v[118:119], v[176:177]
    v_pk_fma_f32 v[168:169], v[128:129], v[128:129], s[68:69]
    v_pk_fma_f32 v[170:171], v[130:131], v[130:131], s[68:69]
    v_pk_fma_f32 v[172:173], v[132:133], v[132:133], s[68:69]
    v_pk_fma_f32 v[174:175], v[134:135], v[134:135], s[68:69]
    v_pk_mul_f32 v[168:169], v[168:169], v[128:129] neg_lo:[1,0] neg_hi:[1,0]
    v_pk_mul_f32 v[170:171], v[170:171], v[130:131] neg_lo:[1,0] neg_hi:[1,0]
    v_pk_mul_f32 v[172:173], v[172:173], v[132:133] neg_lo:[1,0] neg_hi:[1,0]
    v_pk_mul_f32 v[174:175], v[174:175], v[134:135] neg_lo:[1,0] neg_hi:[1,0]
    v_cvt_pk_bf16_f32 v232, v112, v113
    v_cvt_pk_bf16_f32 v233, v114, v115
    v_cvt_pk_bf16_f32 v234, v116, v117
    v_cvt_pk_bf16_f32 v235, v118, v119
    v_mfma_f32_32x32x16_bf16 v[144:159], v[64:67], v[88:91], 0
    ds_write_b32 v181, v180
    v_rcp_f32 v160, v160
    v_rcp_f32 v161, v161
    v_rcp_f32_e64 v162, v162
    v_mfma_f32_32x32x16_bf16 v[144:159], v[68:71], v[92:95], v[144:159]
    v_rcp_f32 v163, v163
    v_rcp_f32 v164, v164
    v_rcp_f32_e64 v165, v165
    v_mfma_f32_32x32x16_bf16 v[144:159], v[72:75], v[96:99], v[144:159]
    v_rcp_f32 v166, v166
    v_rcp_f32 v167, v167
    v_exp_f32 v168, v168
    v_exp_f32 v169, v169
    v_exp_f32 v170, v170
    v_exp_f32 v171, v171
    v_exp_f32 v172, v172
    v_exp_f32 v173, v173
    v_exp_f32 v174, v174
    v_exp_f32 v175, v175
    v_pk_mul_f32 v[120:121], v[120:121], v[160:161]
    v_pk_mul_f32 v[122:123], v[122:123], v[162:163]
    v_pk_mul_f32 v[124:125], v[124:125], v[164:165]
    v_pk_mul_f32 v[126:127], v[126:127], v[166:167]
    v_pk_add_f32 v[168:169], v[168:169], 1.0 op_sel_hi:[1,0]
    v_pk_add_f32 v[170:171], v[170:171], 1.0 op_sel_hi:[1,0]
    v_pk_add_f32 v[172:173], v[172:173], 1.0 op_sel_hi:[1,0]
    v_pk_add_f32 v[174:175], v[174:175], 1.0 op_sel_hi:[1,0]
    v_pk_fma_f32 v[176:177], v[120:121], v[120:121], v[176:177]
    v_pk_fma_f32 v[176:177], v[122:123], v[122:123], v[176:177]
    v_pk_fma_f32 v[176:177], v[124:125], v[124:125], v[176:177]
    v_pk_fma_f32 v[176:177], v[126:127], v[126:127], v[176:177]
    v_pk_fma_f32 v[160:161], v[136:137], v[136:137], s[68:69]
    v_pk_fma_f32 v[162:163], v[138:139], v[138:139], s[68:69]
    v_pk_fma_f32 v[164:165], v[140:141], v[140:141], s[68:69]
    v_pk_fma_f32 v[166:167], v[142:143], v[142:143], s[68:69]
    v_pk_mul_f32 v[160:161], v[160:161], v[136:137] neg_lo:[1,0] neg_hi:[1,0]
    v_pk_mul_f32 v[162:163], v[162:163], v[138:139] neg_lo:[1,0] neg_hi:[1,0]
    v_pk_mul_f32 v[164:165], v[164:165], v[140:141] neg_lo:[1,0] neg_hi:[1,0]
    v_pk_mul_f32 v[166:167], v[166:167], v[142:143] neg_lo:[1,0] neg_hi:[1,0]
    v_cvt_pk_bf16_f32 v236, v120, v121
    v_cvt_pk_bf16_f32 v237, v122, v123
    v_cvt_pk_bf16_f32 v238, v124, v125
    v_cvt_pk_bf16_f32 v239, v126, v127
    v_mfma_f32_32x32x16_bf16 v[144:159], v[76:79], v[100:103], v[144:159]
    v_rcp_f32 v168, v168
    v_rcp_f32 v169, v169
    v_rcp_f32_e64 v170, v170
    v_mfma_f32_32x32x16_bf16 v[144:159], v[80:83], v[104:107], v[144:159]
    v_rcp_f32 v171, v171
    v_rcp_f32 v172, v172
    v_rcp_f32_e64 v173, v173
    v_mfma_f32_32x32x16_bf16 v[144:159], v[84:87], v[108:111], v[144:159]
    v_rcp_f32 v174, v174
    v_rcp_f32 v175, v175
    v_exp_f32 v160, v160
    v_exp_f32 v161, v161
    v_exp_f32 v162, v162
    v_exp_f32 v163, v163
    v_exp_f32 v164, v164
    v_exp_f32 v165, v165
    v_exp_f32 v166, v166
    v_exp_f32 v167, v167
    v_pk_mul_f32 v[128:129], v[128:129], v[168:169]
    v_pk_mul_f32 v[130:131], v[130:131], v[170:171]
    v_pk_mul_f32 v[132:133], v[132:133], v[172:173]
    v_pk_mul_f32 v[134:135], v[134:135], v[174:175]
    v_pk_add_f32 v[160:161], v[160:161], 1.0 op_sel_hi:[1,0]
    v_pk_add_f32 v[162:163], v[162:163], 1.0 op_sel_hi:[1,0]
    v_pk_add_f32 v[164:165], v[164:165], 1.0 op_sel_hi:[1,0]
    v_pk_add_f32 v[166:167], v[166:167], 1.0 op_sel_hi:[1,0]
    v_pk_fma_f32 v[176:177], v[128:129], v[128:129], v[176:177]
    v_pk_fma_f32 v[176:177], v[130:131], v[130:131], v[176:177]
    v_pk_fma_f32 v[176:177], v[132:133], v[132:133], v[176:177]
    v_pk_fma_f32 v[176:177], v[134:135], v[134:135], v[176:177]
    v_pk_fma_f32 v[168:169], v[144:145], v[144:145], s[68:69]
    v_pk_fma_f32 v[170:171], v[146:147], v[146:147], s[68:69]
    v_pk_fma_f32 v[172:173], v[148:149], v[148:149], s[68:69]
    v_pk_fma_f32 v[174:175], v[150:151], v[150:151], s[68:69]
    v_pk_mul_f32 v[168:169], v[168:169], v[144:145] neg_lo:[1,0] neg_hi:[1,0]
    v_pk_mul_f32 v[170:171], v[170:171], v[146:147] neg_lo:[1,0] neg_hi:[1,0]
    v_pk_mul_f32 v[172:173], v[172:173], v[148:149] neg_lo:[1,0] neg_hi:[1,0]
    v_pk_mul_f32 v[174:175], v[174:175], v[150:151] neg_lo:[1,0] neg_hi:[1,0]
    v_cvt_pk_bf16_f32 v240, v128, v129
    v_cvt_pk_bf16_f32 v241, v130, v131
    v_cvt_pk_bf16_f32 v242, v132, v133
    v_cvt_pk_bf16_f32 v243, v134, v135
    v_rcp_f32 v160, v160
    v_rcp_f32 v161, v161
    v_rcp_f32 v162, v162
    v_rcp_f32 v163, v163
    v_rcp_f32 v164, v164
    v_rcp_f32 v165, v165
    v_rcp_f32 v166, v166
    v_rcp_f32 v167, v167
    v_exp_f32 v168, v168
    v_exp_f32 v169, v169
    v_exp_f32 v170, v170
    v_exp_f32 v171, v171
    v_exp_f32 v172, v172
    v_exp_f32 v173, v173
    v_exp_f32 v174, v174
    v_exp_f32 v175, v175
    v_pk_mul_f32 v[136:137], v[136:137], v[160:161]
    v_pk_mul_f32 v[138:139], v[138:139], v[162:163]
    v_pk_mul_f32 v[140:141], v[140:141], v[164:165]
    v_pk_mul_f32 v[142:143], v[142:143], v[166:167]
    v_pk_add_f32 v[168:169], v[168:169], 1.0 op_sel_hi:[1,0]
    v_pk_add_f32 v[170:171], v[170:171], 1.0 op_sel_hi:[1,0]
    v_pk_add_f32 v[172:173], v[172:173], 1.0 op_sel_hi:[1,0]
    v_pk_add_f32 v[174:175], v[174:175], 1.0 op_sel_hi:[1,0]
    v_pk_fma_f32 v[176:177], v[136:137], v[136:137], v[176:177]
    v_pk_fma_f32 v[176:177], v[138:139], v[138:139], v[176:177]
    v_pk_fma_f32 v[176:177], v[140:141], v[140:141], v[176:177]
    v_pk_fma_f32 v[176:177], v[142:143], v[142:143], v[176:177]
    v_pk_fma_f32 v[160:161], v[152:153], v[152:153], s[68:69]
    v_pk_fma_f32 v[162:163], v[154:155], v[154:155], s[68:69]
    v_pk_fma_f32 v[164:165], v[156:157], v[156:157], s[68:69]
    v_pk_fma_f32 v[166:167], v[158:159], v[158:159], s[68:69]
    v_pk_mul_f32 v[160:161], v[160:161], v[152:153] neg_lo:[1,0] neg_hi:[1,0]
    v_pk_mul_f32 v[162:163], v[162:163], v[154:155] neg_lo:[1,0] neg_hi:[1,0]
    v_pk_mul_f32 v[164:165], v[164:165], v[156:157] neg_lo:[1,0] neg_hi:[1,0]
    v_pk_mul_f32 v[166:167], v[166:167], v[158:159] neg_lo:[1,0] neg_hi:[1,0]
    v_cvt_pk_bf16_f32 v244, v136, v137
    v_cvt_pk_bf16_f32 v245, v138, v139
    v_cvt_pk_bf16_f32 v246, v140, v141
    v_cvt_pk_bf16_f32 v247, v142, v143
    v_rcp_f32 v168, v168
    v_rcp_f32 v169, v169
    v_rcp_f32 v170, v170
    v_rcp_f32 v171, v171
    v_rcp_f32 v172, v172
    v_rcp_f32 v173, v173
    v_rcp_f32 v174, v174
    v_rcp_f32 v175, v175
    v_exp_f32 v160, v160
    v_exp_f32 v161, v161
    v_exp_f32 v162, v162
    v_exp_f32 v163, v163
    v_exp_f32 v164, v164
    v_exp_f32 v165, v165
    v_exp_f32 v166, v166
    v_exp_f32 v167, v167
    v_pk_mul_f32 v[144:145], v[144:145], v[168:169]
    v_pk_mul_f32 v[146:147], v[146:147], v[170:171]
    v_pk_mul_f32 v[148:149], v[148:149], v[172:173]
    v_pk_mul_f32 v[150:151], v[150:151], v[174:175]
    v_pk_add_f32 v[160:161], v[160:161], 1.0 op_sel_hi:[1,0]
    v_pk_add_f32 v[162:163], v[162:163], 1.0 op_sel_hi:[1,0]
    v_pk_add_f32 v[164:165], v[164:165], 1.0 op_sel_hi:[1,0]
    v_pk_add_f32 v[166:167], v[166:167], 1.0 op_sel_hi:[1,0]
    v_pk_fma_f32 v[176:177], v[144:145], v[144:145], v[176:177]
    v_pk_fma_f32 v[176:177], v[146:147], v[146:147], v[176:177]
    v_pk_fma_f32 v[176:177], v[148:149], v[148:149], v[176:177]
    v_pk_fma_f32 v[176:177], v[150:151], v[150:151], v[176:177]
    v_cvt_pk_bf16_f32 v248, v144, v145
    v_cvt_pk_bf16_f32 v249, v146, v147
    v_cvt_pk_bf16_f32 v250, v148, v149
    v_cvt_pk_bf16_f32 v251, v150, v151
    v_rcp_f32 v160, v160
    v_rcp_f32 v161, v161
    v_rcp_f32 v162, v162
    v_rcp_f32 v163, v163
    v_rcp_f32 v164, v164
    v_rcp_f32 v165, v165
    v_rcp_f32 v166, v166
    v_rcp_f32 v167, v167
    v_pk_mul_f32 v[152:153], v[152:153], v[160:161]
    v_pk_mul_f32 v[154:155], v[154:155], v[162:163]
    v_pk_mul_f32 v[156:157], v[156:157], v[164:165]
    v_pk_mul_f32 v[158:159], v[158:159], v[166:167]
    v_pk_fma_f32 v[176:177], v[152:153], v[152:153], v[176:177]
    v_pk_fma_f32 v[176:177], v[154:155], v[154:155], v[176:177]
    v_pk_fma_f32 v[176:177], v[156:157], v[156:157], v[176:177]
    v_pk_fma_f32 v[176:177], v[158:159], v[158:159], v[176:177]
    v_add_f32 v180, v176, v177
    v_add_u32 v181, s93, v12
    ds_write_b32 v181, v180
    v_cvt_pk_bf16_f32 v252, v152, v153
    v_cvt_pk_bf16_f32 v253, v154, v155
    v_cvt_pk_bf16_f32 v254, v156, v157
    v_cvt_pk_bf16_f32 v255, v158, v159
    s_cmp_ge_u32 s60, 4
    s_cbranch_scc0 L_chores
L_sk23:
    s_waitcnt lgkmcnt(0)
    s_setprio 0
    s_barrier
    s_cmp_ge_u32 s60, 2
    s_cbranch_scc1 L_sk29
    s_setprio 3
    ds_read_b128 v[20:23], v16 offset:0
    ds_read_b128 v[24:27], v16 offset:1536
    ds_read_b128 v[28:31], v16 offset:3072
    ds_read_b128 v[32:35], v16 offset:4608
    ds_read_b128 v[36:39], v16 offset:6144
    s_waitcnt lgkmcnt(3)
    v_pk_add_f32 v[20:21], v[20:21], v[24:25]
    v_pk_add_f32 v[22:23], v[22:23], v[26:27]
    s_waitcnt lgkmcnt(1)
    v_pk_add_f32 v[28:29], v[28:29], v[32:33]
    v_pk_add_f32 v[30:31], v[30:31], v[34:35]
    s_waitcnt lgkmcnt(0)
    v_pk_add_f32 v[20:21], v[20:21], v[36:37]
    v_pk_add_f32 v[22:23], v[22:23], v[38:39]
    v_pk_add_f32 v[20:21], v[20:21], v[28:29]
    v_pk_add_f32 v[22:23], v[22:23], v[30:31]
    v_and_b32 v20, 0x7fffffff, v20
    v_and_b32 v21, 0x7fffffff, v21
    v_and_b32 v22, 0x7fffffff, v22
    v_and_b32 v23, 0x7fffffff, v23
    s_mov_b64 exec, s[8:9]
    buffer_store_dwordx4 v[20:23], v17, s[44:47], s70 offen
    s_mov_b64 exec, -1
    s_setprio 0
L_sk29:
    s_cmp_lt_u32 s60, 4
    s_cbranch_scc1 L_sk30
    s_mul_i32 s75, s63, 18432
    s_mul_i32 s76, s64, 1536
    s_add_u32 s75, s75, s76
    s_add_u32 s75, s75, 73728
    v_lshl_add_u32 v40, v2, 3, s75
    ds_read_b64_tr_b16 v[52:53], v40 offset:0
    ds_read_b64_tr_b16 v[54:55], v40 offset:3072
    ds_read_b64_tr_b16 v[56:57], v40 offset:512
    ds_read_b64_tr_b16 v[58:59], v40 offset:3584
    ds_read_b64_tr_b16 v[60:61], v40 offset:1024
    ds_read_b64_tr_b16 v[62:63], v40 offset:4096
    ds_read_b64_tr_b16 v[64:65], v40 offset:6144
    ds_read_b64_tr_b16 v[66:67], v40 offset:9216
    ds_read_b64_tr_b16 v[68:69], v40 offset:6656
    ds_read_b64_tr_b16 v[70:71], v40 offset:9728
    ds_read_b64_tr_b16 v[72:73], v40 offset:7168
    ds_read_b64_tr_b16 v[74:75], v40 offset:10240
    ds_read_b64_tr_b16 v[76:77], v40 offset:12288
    ds_read_b64_tr_b16 v[78:79], v40 offset:15360
    ds_read_b64_tr_b16 v[80:81], v40 offset:12800
    ds_read_b64_tr_b16 v[82:83], v40 offset:15872
    ds_read_b64_tr_b16 v[84:85], v40 offset:13312
    ds_read_b64_tr_b16 v[86:87], v40 offset:16384
    ds_add_u32 v6, v13 offset:16
L_rpoll:
    ds_read_b32 v16, v14 offset:16
    s_waitcnt lgkmcnt(0)
    v_readfirstlane_b32 s74, v16
    s_nop 1
    s_cmp_lt_u32 s74, 8
    s_cbranch_scc1 L_rpoll
L_sk30:
    s_and_b32 s74, s60, 6
    s_cmp_eq_u32 s74, 2
    s_cbranch_scc1 L_sk31
    v_and_b32 v40, 15, v2
    v_bfe_u32 v41, v2, 4, 1
    v_lshlrev_b32_e64 v41, 9, v41
    v_lshl_add_u32 v41, v7, 7, v41
    v_lshl_add_u32 v42, v40, 3, v41
    v_xor_b32_e64 v43, 64, v42
    v_add_u32 v43, 256, v43
    s_and_b32 s75, s60, 1
    s_mul_i32 s75, s75, 6144
    s_lshr_b32 s76, s60, 1
    s_cmp_eq_u32 s76, 0
    s_cselect_b32 s77, 3, 0
    s_cmp_eq_u32 s76, 1
    s_cselect_b32 s77, -3, s77
    s_add_u32 s76, s84, s77
    s_mul_i32 s76, s76, 12288
    s_add_u32 s76, s76, s75
    v_add_u32 v44, s76, v42
    v_add_u32 v45, s76, v43
    ds_write2st64_b64 v44, v[184:185], v[188:189] offset0:0 offset1:2
    v_lshlrev_b32_e64 v112, 16, v52
    v_and_b32 v113, 0xffff0000, v52
    v_lshlrev_b32_e64 v114, 16, v53
    v_and_b32 v115, 0xffff0000, v53
    ds_write2st64_b64 v45, v[186:187], v[190:191] offset0:0 offset1:2
    v_lshlrev_b32_e64 v116, 16, v54
    v_and_b32 v117, 0xffff0000, v54
    v_lshlrev_b32_e64 v118, 16, v55
    v_and_b32 v119, 0xffff0000, v55
    ds_write2st64_b64 v44, v[192:193], v[196:197] offset0:4 offset1:6
    v_lshlrev_b32_e64 v120, 16, v56
    v_and_b32 v121, 0xffff0000, v56
    v_lshlrev_b32_e64 v122, 16, v57
    v_and_b32 v123, 0xffff0000, v57
    ds_write2st64_b64 v45, v[194:195], v[198:199] offset0:4 offset1:6
    v_lshlrev_b32_e64 v124, 16, v58
    v_and_b32 v125, 0xffff0000, v58
    v_lshlrev_b32_e64 v126, 16, v59
    v_and_b32 v127, 0xffff0000, v59
    ds_write2st64_b64 v44, v[200:201], v[204:205] offset0:8 offset1:10
    v_lshlrev_b32_e64 v128, 16, v60
    v_and_b32 v129, 0xffff0000, v60
    v_lshlrev_b32_e64 v130, 16, v61
    v_and_b32 v131, 0xffff0000, v61
    ds_write2st64_b64 v45, v[202:203], v[206:207] offset0:8 offset1:10
    v_lshlrev_b32_e64 v132, 16, v62
    v_and_b32 v133, 0xffff0000, v62
    v_lshlrev_b32_e64 v134, 16, v63
    v_and_b32 v135, 0xffff0000, v63
    s_add_u32 s76, s85, s77
    s_mul_i32 s76, s76, 12288
    s_add_u32 s76, s76, s75
    v_add_u32 v44, s76, v42
    v_add_u32 v45, s76, v43
    ds_write2st64_b64 v44, v[208:209], v[212:213] offset0:0 offset1:2
    v_lshlrev_b32_e64 v136, 16, v64
    v_and_b32 v137, 0xffff0000, v64
    v_lshlrev_b32_e64 v138, 16, v65
    v_and_b32 v139, 0xffff0000, v65
    ds_write2st64_b64 v45, v[210:211], v[214:215] offset0:0 offset1:2
    v_lshlrev_b32_e64 v140, 16, v66
    v_and_b32 v141, 0xffff0000, v66
    v_lshlrev_b32_e64 v142, 16, v67
    v_and_b32 v143, 0xffff0000, v67
    ds_write2st64_b64 v44, v[216:217], v[220:221] offset0:4 offset1:6
    v_lshlrev_b32_e64 v144, 16, v68
    v_and_b32 v145, 0xffff0000, v68
    v_lshlrev_b32_e64 v146, 16, v69
    v_and_b32 v147, 0xffff0000, v69
    ds_write2st64_b64 v45, v[218:219], v[222:223] offset0:4 offset1:6
    v_lshlrev_b32_e64 v148, 16, v70
    v_and_b32 v149, 0xffff0000, v70
    v_lshlrev_b32_e64 v150, 16, v71
    v_and_b32 v151, 0xffff0000, v71
    ds_write2st64_b64 v44, v[224:225], v[228:229] offset0:8 offset1:10
    v_lshlrev_b32_e64 v152, 16, v72
    v_and_b32 v153, 0xffff0000, v72
    v_lshlrev_b32_e64 v154, 16, v73
    v_and_b32 v155, 0xffff0000, v73
    ds_write2st64_b64 v45, v[226:227], v[230:231] offset0:8 offset1:10
    v_lshlrev_b32_e64 v156, 16, v74
    v_and_b32 v157, 0xffff0000, v74
    v_lshlrev_b32_e64 v158, 16, v75
    v_and_b32 v159, 0xffff0000, v75
    s_add_u32 s76, s86, s77
    s_mul_i32 s76, s76, 12288
    s_add_u32 s76, s76, s75
    v_add_u32 v44, s76, v42
    v_add_u32 v45, s76, v43
    ds_write2st64_b64 v44, v[232:233], v[236:237] offset0:0 offset1:2
    v_lshlrev_b32_e64 v160, 16, v76
    v_and_b32 v161, 0xffff0000, v76
    v_lshlrev_b32_e64 v162, 16, v77
    v_and_b32 v163, 0xffff0000, v77
    ds_write2st64_b64 v45, v[234:235], v[238:239] offset0:0 offset1:2
    v_lshlrev_b32_e64 v164, 16, v78
    v_and_b32 v165, 0xffff0000, v78
    v_lshlrev_b32_e64 v166, 16, v79
    v_and_b32 v167, 0xffff0000, v79
    ds_write2st64_b64 v44, v[240:241], v[244:245] offset0:4 offset1:6
    v_lshlrev_b32_e64 v168, 16, v80
    v_and_b32 v169, 0xffff0000, v80
    v_lshlrev_b32_e64 v170, 16, v81
    v_and_b32 v171, 0xffff0000, v81
    ds_write2st64_b64 v45, v[242:243], v[246:247] offset0:4 offset1:6
    v_lshlrev_b32_e64 v172, 16, v82
    v_and_b32 v173, 0xffff0000, v82
    v_lshlrev_b32_e64 v174, 16, v83
    v_and_b32 v175, 0xffff0000, v83
    ds_write2st64_b64 v44, v[248:249], v[252:253] offset0:8 offset1:10
    v_lshlrev_b32_e64 v176, 16, v84
    v_and_b32 v177, 0xffff0000, v84
    v_lshlrev_b32_e64 v178, 16, v85
    v_and_b32 v179, 0xffff0000, v85
    ds_write2st64_b64 v45, v[250:251], v[254:255] offset0:8 offset1:10
    v_lshlrev_b32_e64 v180, 16, v86
    v_and_b32 v181, 0xffff0000, v86
    v_lshlrev_b32_e64 v182, 16, v87
    v_and_b32 v183, 0xffff0000, v87
    s_lshl_b32 s74, s64, 2
    v_add_u32 v40, s74, v6
    ds_add_u32 v40, v13 offset:20
L_sk31:
    s_cmp_lg_u32 s60, 2
    s_cbranch_scc1 L_sk32
    s_setprio 3
    s_mov_b32 s6, 0
L_qloop:
    s_cmp_ge_u32 s82, 24
    s_cbranch_scc1 L_qdone
    v_mov_b32 v24, 0
    v_mov_b32 v25, 0
    v_mov_b32 v26, 0
    v_mov_b32 v27, 0
    s_mov_b32 s74, s96
L_cloop:
    s_ff1_i32_b32 s70, s74
    s_bitset0_b32 s74, s70
    s_mov_b32 m0, s70
    s_lshl_b32 s72, s82, 14
    s_movrels_b32 s71, s88
    s_lshl_b32 s73, s70, 11
    s_add_u32 s72, s72, s73
    v_lshrrev_b32 v22, v17, s71
    v_bfe_i32 v23, v22, 16, 1
    v_bfe_i32 v22, v22, 0, 1
L_poll1:
    buffer_load_dwordx4 v[28:31], v16, s[44:47], s72 offen sc1
    buffer_load_dwordx4 v[32:35], v16, s[44:47], s72 offen offset:1024 sc1
    s_waitcnt vmcnt(0)
    v_and_b32 v28, v22, v28
    v_and_b32 v32, v23, v32
    v_and_b32 v29, v22, v29
    v_and_b32 v33, v23, v33
    v_and_b32 v30, v22, v30
    v_and_b32 v34, v23, v34
    v_and_b32 v31, v22, v31
    v_and_b32_e64 v35, v23, v35
    v_or3_b32 v36, v28, v29, v30
    v_or3_b32 v37, v31, v32, v33
    v_or3_b32 v36, v36, v34, v35
    v_or_b32 v36, v36, v37
    v_cmp_gt_i32 vcc, 0, v36
    s_sub_u32 s98, s98, 1
    s_cmp_lt_i32 s98, 0
    s_cbranch_scc1 L_p1done
    s_nop 1
    s_cbranch_vccnz L_poll1
L_p1done:
    v_add_f32 v28, v28, v32
    v_add_f32 v24, v24, v28
    v_add_f32 v29, v29, v33
    v_add_f32 v25, v25, v29
    v_add_f32 v30, v30, v34
    v_add_f32 v26, v26, v30
    v_add_f32 v31, v31, v35
    v_add_f32_e64 v27, v27, v31
    s_cmp_lg_u32 s74, 0
    s_cbranch_scc1 L_cloop
    v_add_f32_dpp v24, v24, v24 row_shr:1 row_mask:0xf bank_mask:0xf bound_ctrl:0
    v_add_f32_dpp v25, v25, v25 row_shr:1 row_mask:0xf bank_mask:0xf bound_ctrl:0
    v_add_f32_dpp v26, v26, v26 row_shr:1 row_mask:0xf bank_mask:0xf bound_ctrl:0
    v_add_f32_dpp v27, v27, v27 row_shr:1 row_mask:0xf bank_mask:0xf bound_ctrl:0
    v_add_f32_dpp v24, v24, v24 row_shr:2 row_mask:0xf bank_mask:0xf bound_ctrl:0
    v_add_f32_dpp v25, v25, v25 row_shr:2 row_mask:0xf bank_mask:0xf bound_ctrl:0
    v_add_f32_dpp v26, v26, v26 row_shr:2 row_mask:0xf bank_mask:0xf bound_ctrl:0
    v_add_f32_dpp v27, v27, v27 row_shr:2 row_mask:0xf bank_mask:0xf bound_ctrl:0
    v_add_f32_dpp v24, v24, v24 row_shr:4 row_mask:0xf bank_mask:0xf bound_ctrl:0
    v_add_f32_dpp v25, v25, v25 row_shr:4 row_mask:0xf bank_mask:0xf bound_ctrl:0
    v_add_f32_dpp v26, v26, v26 row_shr:4 row_mask:0xf bank_mask:0xf bound_ctrl:0
    v_add_f32_dpp v27, v27, v27 row_shr:4 row_mask:0xf bank_mask:0xf bound_ctrl:0
    v_add_f32_dpp v24, v24, v24 row_shr:8 row_mask:0xf bank_mask:0xf bound_ctrl:0
    v_add_f32_dpp v25, v25, v25 row_shr:8 row_mask:0xf bank_mask:0xf bound_ctrl:0
    v_add_f32_dpp v26, v26, v26 row_shr:8 row_mask:0xf bank_mask:0xf bound_ctrl:0
    v_add_f32_dpp v27, v27, v27 row_shr:8 row_mask:0xf bank_mask:0xf bound_ctrl:0
    v_and_b32 v24, 0x7fffffff, v24
    v_and_b32 v25, 0x7fffffff, v25
    v_and_b32 v26, 0x7fffffff, v26
    v_and_b32 v27, 0x7fffffff, v27
    s_lshl_b32 s72, s82, 9
    s_add_u32 s72, s72, 1048576
    s_lshl_b32 s73, s80, 6
    s_add_u32 s73, s73, s72
    s_mov_b32 exec_lo, 0x80008000
    s_mov_b32 exec_hi, 0x80008000
    buffer_store_dwordx4 v[24:27], v19, s[44:47], s73 offen sc1
    s_mov_b64 exec, -1
    s_cmp_eq_u32 s6, 0
    s_cselect_b32 s6, 1, s6
    s_cbranch_scc1 L_tr
L_hop2:
    s_lshl_b32 s72, s82, 9
    s_add_u32 s72, s72, 1048576
    v_mov_b32 v28, 0
    v_mov_b32 v29, 0
    v_mov_b32 v30, 0
    v_mov_b32_e64 v31, 0
    s_lshl_b32 s70, s80, 11
    s_lshl_b32 s73, s82, 6
    s_add_u32 s70, s70, s73
    s_add_u32 s70, s70, 1114112
    s_mov_b64 exec, s[8:9]
L_poll2:
    buffer_load_dwordx4 v[28:31], v18, s[44:47], s72 offen sc1
    s_waitcnt vmcnt(0)
    v_or3_b32 v36, v28, v29, v30
    v_or_b32 v36, v36, v31
    v_cmp_gt_i32 vcc, 0, v36
    s_sub_u32 s98, s98, 1
    s_cmp_lt_i32 s98, 0
    s_cbranch_scc1 L_p2done
    s_nop 1
    s_cbranch_vccnz L_poll2
L_p2done:
    s_mov_b64 exec, -1
    v_add_f32_dpp v28, v28, v28 row_shr:1 row_mask:0xf bank_mask:0xf bound_ctrl:0
    v_add_f32_dpp v29, v29, v29 row_shr:1 row_mask:0xf bank_mask:0xf bound_ctrl:0
    v_add_f32_dpp v30, v30, v30 row_shr:1 row_mask:0xf bank_mask:0xf bound_ctrl:0
    v_add_f32_dpp v31, v31, v31 row_shr:1 row_mask:0xf bank_mask:0xf bound_ctrl:0
    v_add_f32_dpp v28, v28, v28 row_shr:2 row_mask:0xf bank_mask:0xf bound_ctrl:0
    v_add_f32_dpp v29, v29, v29 row_shr:2 row_mask:0xf bank_mask:0xf bound_ctrl:0
    v_add_f32_dpp v30, v30, v30 row_shr:2 row_mask:0xf bank_mask:0xf bound_ctrl:0
    v_add_f32_dpp v31, v31, v31 row_shr:2 row_mask:0xf bank_mask:0xf bound_ctrl:0
    v_add_f32_dpp v28, v28, v28 row_shr:4 row_mask:0xf bank_mask:0xf bound_ctrl:0
    v_add_f32_dpp v29, v29, v29 row_shr:4 row_mask:0xf bank_mask:0xf bound_ctrl:0
    v_add_f32_dpp v30, v30, v30 row_shr:4 row_mask:0xf bank_mask:0xf bound_ctrl:0
    v_add_f32_dpp v31, v31, v31 row_shr:4 row_mask:0xf bank_mask:0xf bound_ctrl:0
    v_and_b32 v28, 0x7fffffff, v28
    v_and_b32 v29, 0x7fffffff, v29
    v_and_b32 v30, 0x7fffffff, v30
    v_and_b32 v31, 0x7fffffff, v31
    s_mov_b32 exec_lo, 0x00800080
    s_mov_b32 exec_hi, 0x00800080
    buffer_store_dwordx4 v[28:31], v19, s[44:47], s70 offen
    s_mov_b64 exec, -1
    s_add_u32 s82, s82, s83
    s_nop 1
    s_branch L_qloop
L_qdone:
    s_cmp_eq_u32 s6, 2
    s_cbranch_scc1 L_trdone
    s_setprio 0
L_sk32:
L_tr:
    v_lshrrev_b32 v47, 4, v2
    s_mul_i32 s75, s63, 192
    s_add_u32 s75, s75, 162880
    v_lshl_add_u32 v40, v47, 3, s75
    ds_read_b64 v[88:89], v40 offset:0
    ds_read_b64 v[90:91], v40 offset:32
    ds_read_b64 v[92:93], v40 offset:64
    ds_read_b64 v[94:95], v40 offset:96
    ds_read_b64 v[96:97], v40 offset:128
    ds_read_b64 v[98:99], v40 offset:160
    v_and_b32 v46, 15, v2
    v_lshlrev_b32 v41, 20, v46
    v_lshl_add_u32 v41, v47, 4, v41
    s_mul_i32 s75, s63, 384
    s_mul_i32 s76, s64, 192
    s_add_u32 s75, s75, s76
    s_add_u32 s75, s75, 161280
    v_add_u32_e64 v41, s75, v41
    s_waitcnt lgkmcnt(0)
    v_mfma_f32_16x16x32_bf16 v[100:103], v[52:55], v[88:91], 0
    v_mfma_f32_16x16x32_bf16 v[104:107], v[56:59], v[88:91], 0
    v_mfma_f32_16x16x32_bf16 v[108:111], v[60:63], v[88:91], 0
    v_mfma_f32_16x16x32_bf16 v[100:103], v[64:67], v[92:95], v[100:103]
    v_mfma_f32_16x16x32_bf16 v[104:107], v[68:71], v[92:95], v[104:107]
    v_mfma_f32_16x16x32_bf16 v[108:111], v[72:75], v[92:95], v[108:111]
    v_mfma_f32_16x16x32_bf16 v[100:103], v[76:79], v[96:99], v[100:103]
    v_mfma_f32_16x16x32_bf16 v[104:107], v[80:83], v[96:99], v[104:107]
    v_mfma_f32_16x16x32_bf16 v[108:111], v[84:87], v[96:99], v[108:111]
    s_nop 5
    ds_write_b128 v41, v[100:103] offset:0
    ds_write_b128 v41, v[104:107] offset:64
    ds_write_b128 v41, v[108:111] offset:128
    ds_add_rtn_u32 v42, v6, v13 offset:4
    s_and_b32 s74, s60, 6
    s_cmp_lg_u32 s74, 2
    s_cbranch_scc1 L_sk33
    v_lshlrev_b32_e64 v112, 16, v52
    v_and_b32 v113, 0xffff0000, v52
    v_lshlrev_b32_e64 v114, 16, v53
    v_and_b32 v115, 0xffff0000, v53
    v_lshlrev_b32_e64 v116, 16, v54
    v_and_b32 v117, 0xffff0000, v54
    v_lshlrev_b32_e64 v118, 16, v55
    v_and_b32 v119, 0xffff0000, v55
    v_lshlrev_b32_e64 v120, 16, v56
    v_and_b32 v121, 0xffff0000, v56
    v_lshlrev_b32_e64 v122, 16, v57
    v_and_b32 v123, 0xffff0000, v57
    v_lshlrev_b32_e64 v124, 16, v58
    v_and_b32 v125, 0xffff0000, v58
    v_lshlrev_b32_e64 v126, 16, v59
    v_and_b32 v127, 0xffff0000, v59
    v_lshlrev_b32_e64 v128, 16, v60
    v_and_b32 v129, 0xffff0000, v60
    v_lshlrev_b32_e64 v130, 16, v61
    v_and_b32 v131, 0xffff0000, v61
    v_lshlrev_b32_e64 v132, 16, v62
    v_and_b32 v133, 0xffff0000, v62
    v_lshlrev_b32_e64 v134, 16, v63
    v_and_b32 v135, 0xffff0000, v63
    v_lshlrev_b32_e64 v136, 16, v64
    v_and_b32 v137, 0xffff0000, v64
    v_lshlrev_b32_e64 v138, 16, v65
    v_and_b32 v139, 0xffff0000, v65
    v_lshlrev_b32_e64 v140, 16, v66
    v_and_b32 v141, 0xffff0000, v66
    v_lshlrev_b32_e64 v142, 16, v67
    v_and_b32 v143, 0xffff0000, v67
    v_lshlrev_b32_e64 v144, 16, v68
    v_and_b32 v145, 0xffff0000, v68
    v_lshlrev_b32_e64 v146, 16, v69
    v_and_b32 v147, 0xffff0000, v69
    v_lshlrev_b32_e64 v148, 16, v70
    v_and_b32 v149, 0xffff0000, v70
    v_lshlrev_b32_e64 v150, 16, v71
    v_and_b32 v151, 0xffff0000, v71
    v_lshlrev_b32_e64 v152, 16, v72
    v_and_b32 v153, 0xffff0000, v72
    v_lshlrev_b32_e64 v154, 16, v73
    v_and_b32 v155, 0xffff0000, v73
    v_lshlrev_b32_e64 v156, 16, v74
    v_and_b32 v157, 0xffff0000, v74
    v_lshlrev_b32_e64 v158, 16, v75
    v_and_b32 v159, 0xffff0000, v75
    v_lshlrev_b32_e64 v160, 16, v76
    v_and_b32 v161, 0xffff0000, v76
    v_lshlrev_b32_e64 v162, 16, v77
    v_and_b32 v163, 0xffff0000, v77
    v_lshlrev_b32_e64 v164, 16, v78
    v_and_b32 v165, 0xffff0000, v78
    v_lshlrev_b32_e64 v166, 16, v79
    v_and_b32 v167, 0xffff0000, v79
    v_lshlrev_b32_e64 v168, 16, v80
    v_and_b32 v169, 0xffff0000, v80
    v_lshlrev_b32_e64 v170, 16, v81
    v_and_b32 v171, 0xffff0000, v81
    v_lshlrev_b32_e64 v172, 16, v82
    v_and_b32 v173, 0xffff0000, v82
    v_lshlrev_b32_e64 v174, 16, v83
    v_and_b32 v175, 0xffff0000, v83
    v_lshlrev_b32_e64 v176, 16, v84
    v_and_b32 v177, 0xffff0000, v84
    v_lshlrev_b32_e64 v178, 16, v85
    v_and_b32 v179, 0xffff0000, v85
    v_lshlrev_b32_e64 v180, 16, v86
    v_and_b32 v181, 0xffff0000, v86
    v_lshlrev_b32_e64 v182, 16, v87
    v_and_b32 v183, 0xffff0000, v87
L_sk33:
    s_waitcnt lgkmcnt(0)
    v_readfirstlane_b32 s70, v42
    s_nop 1
    s_cmp_lg_u32 s70, 7
    s_cbranch_scc1 L_sk34
    v_min_u32 v40, 23, v2
    v_lshlrev_b32_e64 v40, 4, v40
    v_add_u32 v40, 161280, v40
    ds_read_b128 v[88:91], v40 offset:0
    ds_read_b128 v[92:95], v40 offset:384
    ds_read_b128 v[96:99], v40 offset:768
    ds_read_b128 v[100:103], v40 offset:1152
    s_waitcnt lgkmcnt(2)
    v_add_f32 v88, v88, v92
    v_add_f32 v89, v89, v93
    v_add_f32 v90, v90, v94
    v_add_f32 v91, v91, v95
    s_waitcnt lgkmcnt(0)
    v_add_f32 v96, v96, v100
    v_add_f32 v97, v97, v101
    v_add_f32 v98, v98, v102
    v_add_f32 v99, v99, v103
    v_add_f32 v88, v88, v96
    v_add_f32 v89, v89, v97
    v_add_f32 v90, v90, v98
    v_add_f32 v91, v91, v99
    ds_write_b128 v40, v[88:91]
L_sk34:
    s_cmp_lg_u32 s60, 2
    s_cbranch_scc1 L_sk35
    s_cmp_eq_u32 s6, 1
    s_mov_b32 s6, 2
    s_cbranch_scc1 L_hop2
L_sk35:
L_trdone:
    v_and_b32 v40, 3, v2
    v_lshrrev_b32 v41, 2, v2
    v_lshlrev_b32 v42, 2, v40
    v_and_b32 v42, 8, v42
    v_xor_b32 v42, v42, v41
    v_lshlrev_b32_e64 v42, 3, v42
    v_lshl_add_u32 v42, v40, 7, v42
    s_mul_i32 s70, s63, 3
    s_lshl_b32 s71, s64, 1
    s_add_u32 s78, s70, s71
    s_lshl_b32 s70, s78, 10
    v_add_u32_e64 v42, s70, v42
    v_add_u32 v43, 73728, v42
    v_lshlrev_b32_e64 v41, 3, v41
    v_add_u32 v41, 155136, v41
    s_cmp_lt_u32 s60, 4
    s_cbranch_scc1 L_sk36
    ds_read_b64_tr_b16 v[232:233], v41 offset:0
    ds_read_b64_tr_b16 v[234:235], v41 offset:128
    ds_read_b64_tr_b16 v[236:237], v41 offset:256
    ds_read_b64_tr_b16 v[238:239], v41 offset:384
    ds_read_b64_tr_b16 v[240:241], v41 offset:512
    ds_read_b64_tr_b16 v[242:243], v41 offset:640
    ds_read_b64_tr_b16 v[244:245], v41 offset:768
    ds_read_b64_tr_b16 v[246:247], v41 offset:896
    ds_read_b64_tr_b16 v[248:249], v41 offset:1024
    ds_read_b64_tr_b16 v[250:251], v41 offset:1152
    ds_read_b64_tr_b16 v[252:253], v41 offset:1280
    ds_read_b64_tr_b16 v[254:255], v41 offset:1408
    ds_read_b64_tr_b16 v[88:89], v41 offset:1536
    ds_read_b64_tr_b16 v[90:91], v41 offset:1664
    ds_read_b64_tr_b16 v[92:93], v41 offset:1792
    ds_read_b64_tr_b16 v[94:95], v41 offset:1920
    ds_read_b64_tr_b16 v[96:97], v41 offset:2048
    ds_read_b64_tr_b16 v[98:99], v41 offset:2176
    ds_read_b64_tr_b16 v[100:101], v41 offset:2304
    ds_read_b64_tr_b16 v[102:103], v41 offset:2432
    ds_read_b64_tr_b16 v[104:105], v41 offset:2560
    ds_read_b64_tr_b16 v[106:107], v41 offset:2688
    ds_read_b64_tr_b16 v[108:109], v41 offset:2816
    ds_read_b64_tr_b16 v[110:111], v41 offset:2944
L_sk36:
L_hapoll:
    ds_read_b32 v40, v14 offset:20
    s_waitcnt lgkmcnt(0)
    v_readfirstlane_b32 s74, v40
    s_nop 1
    s_cmp_lt_u32 s74, 4
    s_cbranch_scc1 L_hapoll
    ds_read_b64_tr_b16 v[184:185], v42 offset:36864
    ds_read_b64_tr_b16 v[186:187], v42 offset:37376
    ds_read_b64_tr_b16 v[188:189], v42 offset:49152
    ds_read_b64_tr_b16 v[190:191], v42 offset:49664
    ds_read_b64_tr_b16 v[192:193], v42 offset:61440
    ds_read_b64_tr_b16 v[194:195], v42 offset:61952
    ds_read_b64_tr_b16 v[196:197], v42 offset:0
    ds_read_b64_tr_b16 v[198:199], v42 offset:512
    ds_read_b64_tr_b16 v[200:201], v42 offset:12288
    ds_read_b64_tr_b16 v[202:203], v42 offset:12800
    ds_read_b64_tr_b16 v[204:205], v42 offset:24576
    ds_read_b64_tr_b16 v[206:207], v42 offset:25088
    s_cmp_ge_u32 s60, 4
    s_cbranch_scc1 L_sk37
    ds_read_b64_tr_b16 v[232:233], v42 offset:37888
    ds_read_b64_tr_b16 v[234:235], v42 offset:38400
    ds_read_b64_tr_b16 v[236:237], v42 offset:50176
    ds_read_b64_tr_b16 v[238:239], v42 offset:50688
    ds_read_b64_tr_b16 v[240:241], v42 offset:62464
    ds_read_b64_tr_b16 v[242:243], v42 offset:62976
    ds_read_b64_tr_b16 v[244:245], v42 offset:1024
    ds_read_b64_tr_b16 v[246:247], v42 offset:1536
    ds_read_b64_tr_b16 v[248:249], v42 offset:13312
    ds_read_b64_tr_b16 v[250:251], v42 offset:13824
    ds_read_b64_tr_b16 v[252:253], v42 offset:25600
    ds_read_b64_tr_b16 v[254:255], v42 offset:26112
L_sk37:
    v_lshrrev_b32 v44, 1, v2
    v_and_b32 v44, 16, v44
    v_lshlrev_b32 v45, 1, v2
    v_and_or_b32 v44, v45, 32, v44
    s_lshl_b32 s70, s78, 4
    s_add_u32 s71, s70, 16
    s_cmp_eq_u32 s64, 0
    s_cselect_b32 s71, s71, 192
    s_mov_b32 s73, 40320
    v_add_u32 v45, s70, v46
    v_mul_u32_u24 v40, 4682, v45
    v_lshrrev_b32_e64 v40, 16, v40
    v_mad_u32_u24 v45, v45, s67, v44
    v_mad_u32_u24 v4, v40, s73, v45
    v_add_u32_e64 v45, s71, v46
    v_mul_u32_u24 v40, 4682, v45
    v_lshrrev_b32_e64 v40, 16, v40
    v_mad_u32_u24 v45, v45, s67, v44
    v_mad_u32_u24 v5, v40, s73, v45
    s_cmp_lt_u32 s60, 4
    s_cbranch_scc1 L_sk38
    s_cmp_eq_u32 s60, 7
    s_cselect_b32 s70, -1, 3
    v_sub_u32_e64 v45, s70, v46
    v_and_b32 v45, 0x80000000, v45
    v_or_b32 v5, v5, v45
L_sk38:
    v_lshlrev_b32 v45, 2, v47
    v_sub_u32_e64 v45, v46, v45
    v_mov_b32 v40, 0x3f80
    v_mov_b32 v44, 0x3f800000
    v_cmp_eq_u32 vcc, 0, v45
    v_cmp_eq_u32 s[70:71], 1, v45
    s_nop 0
    v_cndmask_b32 v8, 0, v40, vcc
    v_cndmask_b32 v8, v8, v44, s[70:71]
    v_cmp_eq_u32 vcc, 2, v45
    v_cmp_eq_u32 s[70:71], 3, v45
    s_nop 0
    v_cndmask_b32 v9, 0, v40, vcc
    v_cndmask_b32 v9, v9, v44, s[70:71]
    s_mul_i32 s70, s63, 384
    s_add_u32 s70, s70, 159744
    v_lshl_add_u32 v10, v47, 4, s70
    v_lshlrev_b32 v11, 4, v47
    v_add_u32 v11, 161280, v11
    v_lshlrev_b32_e64 v12, 4, v2
    v_add_u32 v12, 73728, v12
    s_mul_i32 s70, s64, 36864
    s_mul_i32 s71, s63, 3072
    s_add_u32 s70, s70, s71
    v_add_u32 v1, s70, v12
    s_cmp_eq_u32 s63, 3
    s_cselect_b32 s84, 0, s63
    s_mul_i32 s84, s84, s64
    s_add_u32 s85, s84, 1
    s_cmp_eq_u32 s85, 3
    s_cselect_b32 s85, 0, s85
    s_add_u32 s86, s85, 1
    s_cmp_eq_u32 s86, 3
    s_cselect_b32 s86, 0, s86
    s_lshl_b32 s88, s84, 6
    s_add_u32 s88, s88, s4
    s_lshl_b32 s91, s84, 7
    s_mul_i32 s84, s84, 24576
    s_lshl_b32 s89, s85, 6
    s_add_u32 s89, s89, s4
    s_lshl_b32 s92, s85, 7
    s_mul_i32 s85, s85, 24576
    s_lshl_b32 s90, s86, 6
    s_add_u32 s90, s90, s4
    s_lshl_b32 s93, s86, 7
    s_mul_i32 s86, s86, 24576
L_hbpoll:
    ds_read_b32 v40, v14 offset:24
    s_waitcnt lgkmcnt(0)
    v_readfirstlane_b32 s74, v40
    s_nop 1
    s_cmp_lt_u32 s74, 4
    s_cbranch_scc1 L_hbpoll
    ds_read_b64_tr_b16 v[208:209], v43 offset:0
    ds_read_b64_tr_b16 v[210:211], v43 offset:512
    ds_read_b64_tr_b16 v[212:213], v43 offset:12288
    ds_read_b64_tr_b16 v[214:215], v43 offset:12800
    ds_read_b64_tr_b16 v[216:217], v43 offset:24576
    ds_read_b64_tr_b16 v[218:219], v43 offset:25088
    ds_read_b64_tr_b16 v[220:221], v43 offset:36864
    ds_read_b64_tr_b16 v[222:223], v43 offset:37376
    ds_read_b64_tr_b16 v[224:225], v43 offset:49152
    ds_read_b64_tr_b16 v[226:227], v43 offset:49664
    ds_read_b64_tr_b16 v[228:229], v43 offset:61440
    ds_read_b64_tr_b16 v[230:231], v43 offset:61952
    s_cmp_ge_u32 s60, 4
    s_cbranch_scc1 L_sk39
    ds_read_b64_tr_b16 v[88:89], v43 offset:1024
    ds_read_b64_tr_b16 v[90:91], v43 offset:1536
    ds_read_b64_tr_b16 v[92:93], v43 offset:13312
    ds_read_b64_tr_b16 v[94:95], v43 offset:13824
    ds_read_b64_tr_b16 v[96:97], v43 offset:25600
    ds_read_b64_tr_b16 v[98:99], v43 offset:26112
    ds_read_b64_tr_b16 v[100:101], v43 offset:37888
    ds_read_b64_tr_b16 v[102:103], v43 offset:38400
    ds_read_b64_tr_b16 v[104:105], v43 offset:50176
    ds_read_b64_tr_b16 v[106:107], v43 offset:50688
    ds_read_b64_tr_b16 v[108:109], v43 offset:62464
    ds_read_b64_tr_b16 v[110:111], v43 offset:62976
L_sk39:
    v_add_u32 v13, s84, v12
    v_add_u32 v6, s91, v11
    v_add_u32 v14, s85, v12
    v_add_u32 v7, s92, v11
    v_add_u32 v15, s86, v12
    v_add_u32_e64 v0, s93, v11
    s_cmp_lg_u32 s60, 3
    s_cbranch_scc1 L_sk40
    s_setprio 3
    s_lshl_b32 s72, s80, 11
    s_add_u32 s72, s72, 1114112
    s_mov_b32 s74, 0x4091afa4
    v_mul_u32_u24 v70, 24, v2
    v_lshlrev_b32 v64, 16, v48
    v_and_b32 v65, 0xffff0000, v48
    v_lshlrev_b32_e64 v66, 16, v49
    v_and_b32 v67, 0xffff0000, v49
    v_lshlrev_b32_e64 v68, 16, v50
    v_and_b32 v69, 0xffff0000, v50
    v_add_u32 v71, 159744, v70
    v_mov_b32 v72, 0x358637bd
    v_mov_b32 v73, 0x40088e99
    v_mov_b32 v74, 0x3b2aaaab
L_poll3:
    buffer_load_dwordx4 v[52:55], v70, s[44:47], s72 offen sc1
    buffer_load_dwordx2 v[56:57], v70, s[44:47], s72 offen offset:16 sc1
    s_waitcnt vmcnt(0)
    v_or3_b32 v60, v52, v53, v54
    v_or3_b32 v61, v55, v56, v57
    v_or_b32 v60, v60, v61
    v_cmp_gt_i32 vcc, 0, v60
    s_sub_u32 s98, s98, 1
    s_cmp_lt_i32 s98, 0
    s_cbranch_scc1 L_p3done
    s_nop 1
    s_cbranch_vccnz L_poll3
L_p3done:
    v_fma_f32 v52, v52, s74, v72
    v_fma_f32 v53, v53, s74, v72
    v_fma_f32 v54, v54, s74, v72
    v_fma_f32 v55, v55, s74, v72
    v_fma_f32 v56, v56, s74, v72
    v_fma_f32 v57, v57, s74, v72
    v_sqrt_f32 v52, v52
    v_sqrt_f32 v53, v53
    v_sqrt_f32 v54, v54
    v_sqrt_f32 v55, v55
    v_sqrt_f32 v56, v56
    v_sqrt_f32 v57, v57
    v_add_f32 v60, v52, v53
    v_add_f32 v61, v54, v55
    v_add_f32 v62, v56, v57
    v_add_f32 v60, v60, v61
    v_add_f32 v60, v60, v62
    v_mul_f32_e64 v52, v52, v64
    s_nop 0
    v_add_f32_dpp v60, v60, v60 row_shr:1 row_mask:0xf bank_mask:0xf bound_ctrl:0
    v_mul_f32 v53, v53, v65
    s_nop 0
    v_add_f32_dpp v60, v60, v60 row_shr:2 row_mask:0xf bank_mask:0xf bound_ctrl:0
    v_mul_f32 v54, v54, v66
    s_nop 0
    v_add_f32_dpp v60, v60, v60 row_shr:4 row_mask:0xf bank_mask:0xf bound_ctrl:0
    v_mul_f32 v55, v55, v67
    s_nop 0
    v_add_f32_dpp v60, v60, v60 row_shr:8 row_mask:0xf bank_mask:0xf bound_ctrl:0
    v_mul_f32 v56, v56, v68
    s_nop 0
    v_add_f32_dpp v60, v60, v60 row_bcast:15 row_mask:0xa bank_mask:0xf
    v_mul_f32 v57, v57, v69
    s_nop 0
    v_add_f32_dpp v60, v60, v60 row_bcast:31 row_mask:0xc bank_mask:0xf
    v_fma_f32 v60, v60, v74, v72
    v_rcp_f32 v60, v60
    s_nop 0
    v_mul_f32 v60, v73, v60
    s_nop 0
    v_readlane_b32 s74, v60, 63
    s_nop 1
    v_fma_f32 v52, v52, s74, v73
    v_fma_f32 v53, v53, s74, v73
    v_fma_f32 v54, v54, s74, v73
    v_fma_f32 v55, v55, s74, v73
    v_fma_f32 v56, v56, s74, v73
    v_fma_f32 v57, v57, s74, v73
    ds_write_b64 v71, v[52:53] offset:0
    ds_write_b64 v71, v[54:55] offset:8
    ds_write_b64 v71, v[56:57] offset:16
    s_setprio 0
L_sk40:
    s_setprio 0
    s_waitcnt vmcnt(0) lgkmcnt(0)
    s_barrier
    ds_read_b128 v[16:19], v10 offset:0
    ds_read_b128 v[20:23], v10 offset:64
    ds_read_b128 v[24:27], v10 offset:128
    ds_read_b128 v[28:31], v10 offset:192
    ds_read_b128 v[32:35], v10 offset:256
    ds_read_b128 v[36:39], v10 offset:320
    ds_read_b128 v[64:67], v6 offset:0
    s_waitcnt lgkmcnt(6)
    v_pk_mul_f32 v[112:113], v[112:113], v[16:17]
    v_pk_mul_f32 v[114:115], v[114:115], v[18:19]
    s_waitcnt lgkmcnt(5)
    v_pk_mul_f32 v[116:117], v[116:117], v[20:21]
    v_pk_mul_f32 v[118:119], v[118:119], v[22:23]
    v_cvt_pk_bf16_f32 v112, v112, v113
    v_cvt_pk_bf16_f32 v113, v114, v115
    v_cvt_pk_bf16_f32 v114, v116, v117
    v_cvt_pk_bf16_f32 v115, v118, v119
    ds_write_b128 v1, v[112:115] offset:0
    v_pk_mul_f32 v[120:121], v[120:121], v[16:17]
    v_pk_mul_f32 v[122:123], v[122:123], v[18:19]
    v_pk_mul_f32 v[124:125], v[124:125], v[20:21]
    v_pk_mul_f32 v[126:127], v[126:127], v[22:23]
    v_cvt_pk_bf16_f32 v120, v120, v121
    v_cvt_pk_bf16_f32 v121, v122, v123
    v_cvt_pk_bf16_f32 v122, v124, v125
    v_cvt_pk_bf16_f32 v123, v126, v127
    ds_write_b128 v1, v[120:123] offset:12288
    v_pk_mul_f32 v[128:129], v[128:129], v[16:17]
    v_pk_mul_f32 v[130:131], v[130:131], v[18:19]
    v_pk_mul_f32 v[132:133], v[132:133], v[20:21]
    v_pk_mul_f32 v[134:135], v[134:135], v[22:23]
    v_cvt_pk_bf16_f32 v128, v128, v129
    v_cvt_pk_bf16_f32 v129, v130, v131
    v_cvt_pk_bf16_f32 v130, v132, v133
    v_cvt_pk_bf16_f32 v131, v134, v135
    ds_write_b128 v1, v[128:131] offset:24576
    s_waitcnt lgkmcnt(7)
    v_pk_mul_f32 v[136:137], v[136:137], v[24:25]
    v_pk_mul_f32 v[138:139], v[138:139], v[26:27]
    s_waitcnt lgkmcnt(6)
    v_pk_mul_f32 v[140:141], v[140:141], v[28:29]
    v_pk_mul_f32 v[142:143], v[142:143], v[30:31]
    v_cvt_pk_bf16_f32 v136, v136, v137
    v_cvt_pk_bf16_f32 v137, v138, v139
    v_cvt_pk_bf16_f32 v138, v140, v141
    v_cvt_pk_bf16_f32 v139, v142, v143
    ds_write_b128 v1, v[136:139] offset:1024
    v_pk_mul_f32 v[144:145], v[144:145], v[24:25]
    v_pk_mul_f32 v[146:147], v[146:147], v[26:27]
    v_pk_mul_f32 v[148:149], v[148:149], v[28:29]
    v_pk_mul_f32 v[150:151], v[150:151], v[30:31]
    v_cvt_pk_bf16_f32 v144, v144, v145
    v_cvt_pk_bf16_f32 v145, v146, v147
    v_cvt_pk_bf16_f32 v146, v148, v149
    v_cvt_pk_bf16_f32 v147, v150, v151
    ds_write_b128 v1, v[144:147] offset:13312
    v_pk_mul_f32 v[152:153], v[152:153], v[24:25]
    v_pk_mul_f32 v[154:155], v[154:155], v[26:27]
    v_pk_mul_f32 v[156:157], v[156:157], v[28:29]
    v_pk_mul_f32 v[158:159], v[158:159], v[30:31]
    v_cvt_pk_bf16_f32 v152, v152, v153
    v_cvt_pk_bf16_f32 v153, v154, v155
    v_cvt_pk_bf16_f32 v154, v156, v157
    v_cvt_pk_bf16_f32 v155, v158, v159
    ds_write_b128 v1, v[152:155] offset:25600
    s_waitcnt lgkmcnt(8)
    v_pk_mul_f32 v[160:161], v[160:161], v[32:33]
    v_pk_mul_f32 v[162:163], v[162:163], v[34:35]
    s_waitcnt lgkmcnt(7)
    v_pk_mul_f32 v[164:165], v[164:165], v[36:37]
    v_pk_mul_f32 v[166:167], v[166:167], v[38:39]
    v_cvt_pk_bf16_f32 v160, v160, v161
    v_cvt_pk_bf16_f32 v161, v162, v163
    v_cvt_pk_bf16_f32 v162, v164, v165
    v_cvt_pk_bf16_f32 v163, v166, v167
    ds_write_b128 v1, v[160:163] offset:2048
    v_pk_mul_f32 v[168:169], v[168:169], v[32:33]
    v_pk_mul_f32 v[170:171], v[170:171], v[34:35]
    v_pk_mul_f32 v[172:173], v[172:173], v[36:37]
    v_pk_mul_f32 v[174:175], v[174:175], v[38:39]
    v_cvt_pk_bf16_f32 v168, v168, v169
    v_cvt_pk_bf16_f32 v169, v170, v171
    v_cvt_pk_bf16_f32 v170, v172, v173
    v_cvt_pk_bf16_f32 v171, v174, v175
    ds_write_b128 v1, v[168:171] offset:14336
    v_pk_mul_f32 v[176:177], v[176:177], v[32:33]
    v_pk_mul_f32 v[178:179], v[178:179], v[34:35]
    v_pk_mul_f32 v[180:181], v[180:181], v[36:37]
    v_pk_mul_f32 v[182:183], v[182:183], v[38:39]
    v_cvt_pk_bf16_f32 v176, v176, v177
    v_cvt_pk_bf16_f32 v177, v178, v179
    v_cvt_pk_bf16_f32 v178, v180, v181
    v_cvt_pk_bf16_f32 v179, v182, v183
    ds_write_b128 v1, v[176:179] offset:26624
    buffer_load_dwordx4 v[40:43], v4, s[24:27], s88 offen
    buffer_load_dwordx4 v[44:47], v5, s[24:27], s88 offen
    s_waitcnt lgkmcnt(0)
    s_barrier
    s_cmp_ge_u32 s60, 4
    s_cbranch_scc1 L_late
    ds_read_b128 v[112:115], v13 offset:0
    ds_read_b128 v[116:119], v13 offset:1024
    ds_read_b128 v[120:123], v13 offset:2048
    ds_read_b128 v[124:127], v13 offset:3072
    ds_read_b128 v[128:131], v13 offset:4096
    ds_read_b128 v[132:135], v13 offset:5120
    ds_read_b128 v[136:139], v13 offset:6144
    ds_read_b128 v[140:143], v13 offset:7168
    buffer_load_dwordx4 v[48:51], v4, s[24:27], s89 offen
    buffer_load_dwordx4 v[52:55], v5, s[24:27], s89 offen
    buffer_load_dwordx4 v[56:59], v4, s[24:27], s90 offen
    buffer_load_dwordx4 v[60:63], v5, s[24:27], s90 offen
    s_waitcnt lgkmcnt(7)
    v_mfma_f32_16x16x32_bf16 v[160:163], v[112:115], v[184:187], v[64:67]
    ds_read_b128 v[144:147], v13 offset:8192
    v_mov_b32_e64 v24, v8
    v_mfma_f32_16x16x32_bf16 v[164:167], v[112:115], v[232:235], v[64:67]
    ds_read_b128 v[148:151], v13 offset:9216
    v_mov_b32 v25, v9
    s_waitcnt lgkmcnt(8)
    v_mfma_f32_16x16x32_bf16 v[160:163], v[116:119], v[188:191], v[160:163]
    ds_read_b128 v[152:155], v13 offset:10240
    v_mov_b32_e64 v26, 0
    v_mfma_f32_16x16x32_bf16 v[164:167], v[116:119], v[236:239], v[164:167]
    ds_read_b128 v[156:159], v13 offset:11264
    s_waitcnt lgkmcnt(9)
    v_mfma_f32_16x16x32_bf16 v[160:163], v[120:123], v[192:195], v[160:163]
    ds_read_b128 v[68:71], v6 offset:64
    v_mov_b32 v27, 0
    v_mfma_f32_16x16x32_bf16 v[164:167], v[120:123], v[240:243], v[164:167]
    ds_read_b128 v[72:75], v7 offset:0
    v_mov_b32 v28, v8
    s_waitcnt lgkmcnt(10)
    v_mfma_f32_16x16x32_bf16 v[160:163], v[124:127], v[196:199], v[160:163]
    ds_read_b128 v[76:79], v7 offset:64
    v_mov_b32_e64 v29, v9
    v_mfma_f32_16x16x32_bf16 v[164:167], v[124:127], v[244:247], v[164:167]
    s_waitcnt lgkmcnt(7)
    v_mfma_f32_16x16x32_bf16 v[160:163], v[128:131], v[200:203], v[160:163]
    ds_read_b128 v[112:115], v13 offset:12288
    v_mfma_f32_16x16x32_bf16 v[164:167], v[128:131], v[248:251], v[164:167]
    ds_read_b128 v[116:119], v13 offset:13312
    v_mfma_f32_16x16x32_bf16 v[160:163], v[132:135], v[204:207], v[160:163]
    ds_read_b128 v[120:123], v13 offset:14336
    v_mfma_f32_16x16x32_bf16 v[164:167], v[132:135], v[252:255], v[164:167]
    ds_read_b128 v[124:127], v13 offset:15360
    v_mfma_f32_16x16x32_bf16 v[160:163], v[136:139], v[208:211], v[160:163]
    ds_read_b128 v[80:83], v0 offset:0
    v_mfma_f32_16x16x32_bf16 v[164:167], v[136:139], v[88:91], v[164:167]
    ds_read_b128 v[84:87], v0 offset:64
    v_mfma_f32_16x16x32_bf16 v[160:163], v[140:143], v[212:215], v[160:163]
    v_mfma_f32_16x16x32_bf16 v[164:167], v[140:143], v[92:95], v[164:167]
    s_waitcnt lgkmcnt(9)
    v_mfma_f32_16x16x32_bf16 v[160:163], v[144:147], v[216:219], v[160:163]
    ds_read_b128 v[128:131], v13 offset:16384
    v_mfma_f32_16x16x32_bf16 v[164:167], v[144:147], v[96:99], v[164:167]
    ds_read_b128 v[132:135], v13 offset:17408
    v_mfma_f32_16x16x32_bf16 v[160:163], v[148:151], v[220:223], v[160:163]
    ds_read_b128 v[136:139], v13 offset:18432
    v_mfma_f32_16x16x32_bf16 v[164:167], v[148:151], v[100:103], v[164:167]
    ds_read_b128 v[140:143], v13 offset:19456
    v_mfma_f32_16x16x32_bf16 v[160:163], v[152:155], v[224:227], v[160:163]
    v_mfma_f32_16x16x32_bf16 v[164:167], v[152:155], v[104:107], v[164:167]
    v_mfma_f32_16x16x32_bf16 v[160:163], v[156:159], v[228:231], v[160:163]
    v_mfma_f32_16x16x32_bf16 v[164:167], v[156:159], v[108:111], v[164:167]
    s_waitcnt lgkmcnt(6)
    v_mfma_f32_16x16x32_bf16 v[168:171], v[112:115], v[184:187], v[68:71]
    ds_read_b128 v[144:147], v13 offset:20480
    v_mfma_f32_16x16x32_bf16 v[172:175], v[112:115], v[232:235], v[68:71]
    ds_read_b128 v[148:151], v13 offset:21504
    v_mfma_f32_16x16x32_bf16 v[168:171], v[116:119], v[188:191], v[168:171]
    ds_read_b128 v[152:155], v13 offset:22528
    v_mfma_f32_16x16x32_bf16 v[172:175], v[116:119], v[236:239], v[172:175]
    ds_read_b128 v[156:159], v13 offset:23552
    v_mfma_f32_16x16x32_bf16 v[168:171], v[120:123], v[192:195], v[168:171]
    v_mfma_f32_16x16x32_bf16 v[172:175], v[120:123], v[240:243], v[172:175]
    v_mfma_f32_16x16x32_bf16 v[168:171], v[124:127], v[196:199], v[168:171]
    v_mfma_f32_16x16x32_bf16 v[172:175], v[124:127], v[244:247], v[172:175]
    s_waitcnt lgkmcnt(4)
    v_mfma_f32_16x16x32_bf16 v[168:171], v[128:131], v[200:203], v[168:171]
    ds_read_b128 v[112:115], v14 offset:0
    s_waitcnt vmcnt(5)
    v_permlane16_swap_b32 v40, v42
    v_mfma_f32_16x16x32_bf16 v[172:175], v[128:131], v[248:251], v[172:175]
    ds_read_b128 v[116:119], v14 offset:1024
    v_mfma_f32_16x16x32_bf16 v[168:171], v[132:135], v[204:207], v[168:171]
    ds_read_b128 v[120:123], v14 offset:2048
    v_permlane16_swap_b32_e64 v41, v43
    v_mfma_f32_16x16x32_bf16 v[172:175], v[132:135], v[252:255], v[172:175]
    ds_read_b128 v[124:127], v14 offset:3072
    v_mfma_f32_16x16x32_bf16 v[168:171], v[136:139], v[208:211], v[168:171]
    s_waitcnt vmcnt(4)
    v_permlane16_swap_b32 v44, v46
    v_mfma_f32_16x16x32_bf16 v[172:175], v[136:139], v[88:91], v[172:175]
    v_mfma_f32_16x16x32_bf16 v[168:171], v[140:143], v[212:215], v[168:171]
    v_permlane16_swap_b32_e64 v45, v47
    v_mfma_f32_16x16x32_bf16 v[172:175], v[140:143], v[92:95], v[172:175]
    s_waitcnt lgkmcnt(4)
    v_mfma_f32_16x16x32_bf16 v[160:163], v[24:27], v[40:43], v[160:163]
    ds_read_b128 v[128:131], v14 offset:4096
    v_mfma_f32_16x16x32_bf16 v[164:167], v[24:27], v[44:47], v[164:167]
    ds_read_b128 v[132:135], v14 offset:5120
    v_mfma_f32_16x16x32_bf16 v[168:171], v[26:29], v[40:43], v[168:171]
    ds_read_b128 v[136:139], v14 offset:6144
    v_mfma_f32_16x16x32_bf16 v[172:175], v[26:29], v[44:47], v[172:175]
    ds_read_b128 v[140:143], v14 offset:7168
    v_mfma_f32_16x16x32_bf16 v[168:171], v[144:147], v[216:219], v[168:171]
    v_mfma_f32_16x16x32_bf16 v[172:175], v[144:147], v[96:99], v[172:175]
    v_mfma_f32_16x16x32_bf16 v[168:171], v[148:151], v[220:223], v[168:171]
    v_mfma_f32_16x16x32_bf16 v[172:175], v[148:151], v[100:103], v[172:175]
    v_mfma_f32_16x16x32_bf16 v[168:171], v[152:155], v[224:227], v[168:171]
    v_mfma_f32_16x16x32_bf16 v[172:175], v[152:155], v[104:107], v[172:175]
    v_mfma_f32_16x16x32_bf16 v[168:171], v[156:159], v[228:231], v[168:171]
    v_mfma_f32_16x16x32_bf16 v[172:175], v[156:159], v[108:111], v[172:175]
    s_waitcnt lgkmcnt(4)
    v_mfma_f32_16x16x32_bf16 v[176:179], v[112:115], v[184:187], v[72:75]
    ds_read_b128 v[144:147], v14 offset:8192
    v_mfma_f32_16x16x32_bf16 v[180:183], v[112:115], v[232:235], v[72:75]
    ds_read_b128 v[148:151], v14 offset:9216
    v_mfma_f32_16x16x32_bf16 v[176:179], v[116:119], v[188:191], v[176:179]
    ds_read_b128 v[152:155], v14 offset:10240
    v_mfma_f32_16x16x32_bf16 v[180:183], v[116:119], v[236:239], v[180:183]
    ds_read_b128 v[156:159], v14 offset:11264
    v_mfma_f32_16x16x32_bf16 v[176:179], v[120:123], v[192:195], v[176:179]
    v_mfma_f32_16x16x32_bf16 v[180:183], v[120:123], v[240:243], v[180:183]
    v_mfma_f32_16x16x32_bf16 v[176:179], v[124:127], v[196:199], v[176:179]
    v_mfma_f32_16x16x32_bf16 v[180:183], v[124:127], v[244:247], v[180:183]
    s_waitcnt lgkmcnt(4)
    v_mfma_f32_16x16x32_bf16 v[176:179], v[128:131], v[200:203], v[176:179]
    ds_read_b128 v[112:115], v14 offset:12288
    v_cvt_pk_bf16_f32 v16, v160, v161
    v_cvt_pk_bf16_f32 v17, v162, v163
    v_mfma_f32_16x16x32_bf16 v[180:183], v[128:131], v[248:251], v[180:183]
    ds_read_b128 v[116:119], v14 offset:13312
    v_cvt_pk_bf16_f32 v20, v164, v165
    v_cvt_pk_bf16_f32 v21, v166, v167
    v_mfma_f32_16x16x32_bf16 v[176:179], v[132:135], v[204:207], v[176:179]
    ds_read_b128 v[120:123], v14 offset:14336
    v_cvt_pk_bf16_f32 v18, v168, v169
    v_cvt_pk_bf16_f32 v19, v170, v171
    v_mfma_f32_16x16x32_bf16 v[180:183], v[132:135], v[252:255], v[180:183]
    ds_read_b128 v[124:127], v14 offset:15360
    v_cvt_pk_bf16_f32 v22, v172, v173
    v_mfma_f32_16x16x32_bf16 v[176:179], v[136:139], v[208:211], v[176:179]
    v_cvt_pk_bf16_f32 v23, v174, v175
    v_permlane16_swap_b32 v16, v18
    v_mfma_f32_16x16x32_bf16 v[180:183], v[136:139], v[88:91], v[180:183]
    v_permlane16_swap_b32_e64 v17, v19
    buffer_store_dwordx4 v[16:19], v4, s[40:43], s88 offen sc0 sc1
    v_mfma_f32_16x16x32_bf16 v[176:179], v[140:143], v[212:215], v[176:179]
    v_permlane16_swap_b32 v20, v22
    v_permlane16_swap_b32 v21, v23
    v_mfma_f32_16x16x32_bf16 v[180:183], v[140:143], v[92:95], v[180:183]
    s_waitcnt lgkmcnt(4)
    buffer_store_dwordx4 v[20:23], v5, s[40:43], s88 offen sc0 sc1
    v_mfma_f32_16x16x32_bf16 v[176:179], v[144:147], v[216:219], v[176:179]
    ds_read_b128 v[128:131], v14 offset:16384
    v_mfma_f32_16x16x32_bf16 v[180:183], v[144:147], v[96:99], v[180:183]
    ds_read_b128 v[132:135], v14 offset:17408
    v_mfma_f32_16x16x32_bf16 v[176:179], v[148:151], v[220:223], v[176:179]
    ds_read_b128 v[136:139], v14 offset:18432
    v_mfma_f32_16x16x32_bf16 v[180:183], v[148:151], v[100:103], v[180:183]
    ds_read_b128 v[140:143], v14 offset:19456
    v_mfma_f32_16x16x32_bf16 v[176:179], v[152:155], v[224:227], v[176:179]
    v_mfma_f32_16x16x32_bf16 v[180:183], v[152:155], v[104:107], v[180:183]
    v_mfma_f32_16x16x32_bf16 v[176:179], v[156:159], v[228:231], v[176:179]
    v_mfma_f32_16x16x32_bf16 v[180:183], v[156:159], v[108:111], v[180:183]
    s_waitcnt lgkmcnt(4)
    v_mfma_f32_16x16x32_bf16 v[160:163], v[112:115], v[184:187], v[76:79]
    ds_read_b128 v[144:147], v14 offset:20480
    v_mfma_f32_16x16x32_bf16 v[164:167], v[112:115], v[232:235], v[76:79]
    ds_read_b128 v[148:151], v14 offset:21504
    v_mfma_f32_16x16x32_bf16 v[160:163], v[116:119], v[188:191], v[160:163]
    ds_read_b128 v[152:155], v14 offset:22528
    v_mfma_f32_16x16x32_bf16 v[164:167], v[116:119], v[236:239], v[164:167]
    ds_read_b128 v[156:159], v14 offset:23552
    v_mfma_f32_16x16x32_bf16 v[160:163], v[120:123], v[192:195], v[160:163]
    v_mfma_f32_16x16x32_bf16 v[164:167], v[120:123], v[240:243], v[164:167]
    v_mfma_f32_16x16x32_bf16 v[160:163], v[124:127], v[196:199], v[160:163]
    v_mfma_f32_16x16x32_bf16 v[164:167], v[124:127], v[244:247], v[164:167]
    s_waitcnt lgkmcnt(4)
    v_mfma_f32_16x16x32_bf16 v[160:163], v[128:131], v[200:203], v[160:163]
    ds_read_b128 v[112:115], v15 offset:0
    s_waitcnt vmcnt(5)
    v_permlane16_swap_b32_e64 v48, v50
    v_mfma_f32_16x16x32_bf16 v[164:167], v[128:131], v[248:251], v[164:167]
    ds_read_b128 v[116:119], v15 offset:1024
    v_mfma_f32_16x16x32_bf16 v[160:163], v[132:135], v[204:207], v[160:163]
    ds_read_b128 v[120:123], v15 offset:2048
    v_permlane16_swap_b32_e64 v49, v51
    v_mfma_f32_16x16x32_bf16 v[164:167], v[132:135], v[252:255], v[164:167]
    ds_read_b128 v[124:127], v15 offset:3072
    v_mfma_f32_16x16x32_bf16 v[160:163], v[136:139], v[208:211], v[160:163]
    s_waitcnt vmcnt(4)
    v_permlane16_swap_b32 v52, v54
    v_mfma_f32_16x16x32_bf16 v[164:167], v[136:139], v[88:91], v[164:167]
    v_mfma_f32_16x16x32_bf16 v[160:163], v[140:143], v[212:215], v[160:163]
    v_permlane16_swap_b32_e64 v53, v55
    v_mfma_f32_16x16x32_bf16 v[164:167], v[140:143], v[92:95], v[164:167]
    s_waitcnt lgkmcnt(4)
    v_mfma_f32_16x16x32_bf16 v[176:179], v[24:27], v[48:51], v[176:179]
    ds_read_b128 v[128:131], v15 offset:4096
    v_mfma_f32_16x16x32_bf16 v[180:183], v[24:27], v[52:55], v[180:183]
    ds_read_b128 v[132:135], v15 offset:5120
    v_mfma_f32_16x16x32_bf16 v[160:163], v[26:29], v[48:51], v[160:163]
    ds_read_b128 v[136:139], v15 offset:6144
    v_mfma_f32_16x16x32_bf16 v[164:167], v[26:29], v[52:55], v[164:167]
    ds_read_b128 v[140:143], v15 offset:7168
    v_mfma_f32_16x16x32_bf16 v[160:163], v[144:147], v[216:219], v[160:163]
    v_mfma_f32_16x16x32_bf16 v[164:167], v[144:147], v[96:99], v[164:167]
    v_mfma_f32_16x16x32_bf16 v[160:163], v[148:151], v[220:223], v[160:163]
    v_mfma_f32_16x16x32_bf16 v[164:167], v[148:151], v[100:103], v[164:167]
    v_mfma_f32_16x16x32_bf16 v[160:163], v[152:155], v[224:227], v[160:163]
    v_mfma_f32_16x16x32_bf16 v[164:167], v[152:155], v[104:107], v[164:167]
    v_mfma_f32_16x16x32_bf16 v[160:163], v[156:159], v[228:231], v[160:163]
    v_mfma_f32_16x16x32_bf16 v[164:167], v[156:159], v[108:111], v[164:167]
    s_waitcnt lgkmcnt(4)
    v_mfma_f32_16x16x32_bf16 v[168:171], v[112:115], v[184:187], v[80:83]
    ds_read_b128 v[144:147], v15 offset:8192
    v_mfma_f32_16x16x32_bf16 v[172:175], v[112:115], v[232:235], v[80:83]
    ds_read_b128 v[148:151], v15 offset:9216
    v_mfma_f32_16x16x32_bf16 v[168:171], v[116:119], v[188:191], v[168:171]
    ds_read_b128 v[152:155], v15 offset:10240
    v_mfma_f32_16x16x32_bf16 v[172:175], v[116:119], v[236:239], v[172:175]
    ds_read_b128 v[156:159], v15 offset:11264
    v_mfma_f32_16x16x32_bf16 v[168:171], v[120:123], v[192:195], v[168:171]
    v_mfma_f32_16x16x32_bf16 v[172:175], v[120:123], v[240:243], v[172:175]
    v_mfma_f32_16x16x32_bf16 v[168:171], v[124:127], v[196:199], v[168:171]
    v_mfma_f32_16x16x32_bf16 v[172:175], v[124:127], v[244:247], v[172:175]
    s_waitcnt lgkmcnt(4)
    v_mfma_f32_16x16x32_bf16 v[168:171], v[128:131], v[200:203], v[168:171]
    ds_read_b128 v[112:115], v15 offset:12288
    v_cvt_pk_bf16_f32 v16, v176, v177
    v_cvt_pk_bf16_f32 v17, v178, v179
    v_mfma_f32_16x16x32_bf16 v[172:175], v[128:131], v[248:251], v[172:175]
    ds_read_b128 v[116:119], v15 offset:13312
    v_cvt_pk_bf16_f32 v20, v180, v181
    v_cvt_pk_bf16_f32 v21, v182, v183
    v_mfma_f32_16x16x32_bf16 v[168:171], v[132:135], v[204:207], v[168:171]
    ds_read_b128 v[120:123], v15 offset:14336
    v_cvt_pk_bf16_f32 v18, v160, v161
    v_cvt_pk_bf16_f32 v19, v162, v163
    v_mfma_f32_16x16x32_bf16 v[172:175], v[132:135], v[252:255], v[172:175]
    ds_read_b128 v[124:127], v15 offset:15360
    v_cvt_pk_bf16_f32 v22, v164, v165
    v_mfma_f32_16x16x32_bf16 v[168:171], v[136:139], v[208:211], v[168:171]
    v_cvt_pk_bf16_f32 v23, v166, v167
    v_permlane16_swap_b32 v16, v18
    v_mfma_f32_16x16x32_bf16 v[172:175], v[136:139], v[88:91], v[172:175]
    v_permlane16_swap_b32_e64 v17, v19
    buffer_store_dwordx4 v[16:19], v4, s[40:43], s89 offen sc0 sc1
    v_mfma_f32_16x16x32_bf16 v[168:171], v[140:143], v[212:215], v[168:171]
    v_permlane16_swap_b32 v20, v22
    v_permlane16_swap_b32 v21, v23
    v_mfma_f32_16x16x32_bf16 v[172:175], v[140:143], v[92:95], v[172:175]
    s_waitcnt lgkmcnt(4)
    buffer_store_dwordx4 v[20:23], v5, s[40:43], s89 offen sc0 sc1
    v_mfma_f32_16x16x32_bf16 v[168:171], v[144:147], v[216:219], v[168:171]
    ds_read_b128 v[128:131], v15 offset:16384
    v_mfma_f32_16x16x32_bf16 v[172:175], v[144:147], v[96:99], v[172:175]
    ds_read_b128 v[132:135], v15 offset:17408
    v_mfma_f32_16x16x32_bf16 v[168:171], v[148:151], v[220:223], v[168:171]
    ds_read_b128 v[136:139], v15 offset:18432
    v_mfma_f32_16x16x32_bf16 v[172:175], v[148:151], v[100:103], v[172:175]
    ds_read_b128 v[140:143], v15 offset:19456
    v_mfma_f32_16x16x32_bf16 v[168:171], v[152:155], v[224:227], v[168:171]
    v_mfma_f32_16x16x32_bf16 v[172:175], v[152:155], v[104:107], v[172:175]
    v_mfma_f32_16x16x32_bf16 v[168:171], v[156:159], v[228:231], v[168:171]
    v_mfma_f32_16x16x32_bf16 v[172:175], v[156:159], v[108:111], v[172:175]
    s_waitcnt lgkmcnt(4)
    v_mfma_f32_16x16x32_bf16 v[176:179], v[112:115], v[184:187], v[84:87]
    ds_read_b128 v[144:147], v15 offset:20480
    v_mfma_f32_16x16x32_bf16 v[180:183], v[112:115], v[232:235], v[84:87]
    ds_read_b128 v[148:151], v15 offset:21504
    v_mfma_f32_16x16x32_bf16 v[176:179], v[116:119], v[188:191], v[176:179]
    ds_read_b128 v[152:155], v15 offset:22528
    v_mfma_f32_16x16x32_bf16 v[180:183], v[116:119], v[236:239], v[180:183]
    ds_read_b128 v[156:159], v15 offset:23552
    v_mfma_f32_16x16x32_bf16 v[176:179], v[120:123], v[192:195], v[176:179]
    v_mfma_f32_16x16x32_bf16 v[180:183], v[120:123], v[240:243], v[180:183]
    v_mfma_f32_16x16x32_bf16 v[176:179], v[124:127], v[196:199], v[176:179]
    v_mfma_f32_16x16x32_bf16 v[180:183], v[124:127], v[244:247], v[180:183]
    s_waitcnt lgkmcnt(4)
    v_mfma_f32_16x16x32_bf16 v[176:179], v[128:131], v[200:203], v[176:179]
    s_waitcnt vmcnt(5)
    v_permlane16_swap_b32_e64 v56, v58
    v_mfma_f32_16x16x32_bf16 v[180:183], v[128:131], v[248:251], v[180:183]
    v_mfma_f32_16x16x32_bf16 v[176:179], v[132:135], v[204:207], v[176:179]
    v_permlane16_swap_b32_e64 v57, v59
    v_mfma_f32_16x16x32_bf16 v[180:183], v[132:135], v[252:255], v[180:183]
    v_mfma_f32_16x16x32_bf16 v[176:179], v[136:139], v[208:211], v[176:179]
    s_waitcnt vmcnt(4)
    v_permlane16_swap_b32 v60, v62
    v_mfma_f32_16x16x32_bf16 v[180:183], v[136:139], v[88:91], v[180:183]
    v_mfma_f32_16x16x32_bf16 v[176:179], v[140:143], v[212:215], v[176:179]
    v_permlane16_swap_b32_e64 v61, v63
    v_mfma_f32_16x16x32_bf16 v[180:183], v[140:143], v[92:95], v[180:183]
    s_waitcnt lgkmcnt(0)
    v_mfma_f32_16x16x32_bf16 v[168:171], v[24:27], v[56:59], v[168:171]
    v_mfma_f32_16x16x32_bf16 v[172:175], v[24:27], v[60:63], v[172:175]
    v_mfma_f32_16x16x32_bf16 v[176:179], v[26:29], v[56:59], v[176:179]
    v_mfma_f32_16x16x32_bf16 v[180:183], v[26:29], v[60:63], v[180:183]
    v_mfma_f32_16x16x32_bf16 v[176:179], v[144:147], v[216:219], v[176:179]
    v_mfma_f32_16x16x32_bf16 v[180:183], v[144:147], v[96:99], v[180:183]
    v_mfma_f32_16x16x32_bf16 v[176:179], v[148:151], v[220:223], v[176:179]
    v_mfma_f32_16x16x32_bf16 v[180:183], v[148:151], v[100:103], v[180:183]
    v_mfma_f32_16x16x32_bf16 v[176:179], v[152:155], v[224:227], v[176:179]
    v_mfma_f32_16x16x32_bf16 v[180:183], v[152:155], v[104:107], v[180:183]
    v_mfma_f32_16x16x32_bf16 v[176:179], v[156:159], v[228:231], v[176:179]
    v_mfma_f32_16x16x32_bf16 v[180:183], v[156:159], v[108:111], v[180:183]
    v_cvt_pk_bf16_f32 v16, v168, v169
    v_cvt_pk_bf16_f32 v17, v170, v171
    v_cvt_pk_bf16_f32 v20, v172, v173
    v_cvt_pk_bf16_f32 v21, v174, v175
    s_nop 2
    v_cvt_pk_bf16_f32 v18, v176, v177
    v_cvt_pk_bf16_f32 v19, v178, v179
    v_cvt_pk_bf16_f32 v22, v180, v181
    v_cvt_pk_bf16_f32 v23, v182, v183
    v_permlane16_swap_b32 v16, v18
    v_permlane16_swap_b32 v17, v19
    buffer_store_dwordx4 v[16:19], v4, s[40:43], s90 offen sc0 sc1
    v_permlane16_swap_b32 v20, v22
    v_permlane16_swap_b32 v21, v23
    buffer_store_dwordx4 v[20:23], v5, s[40:43], s90 offen sc0 sc1
    s_endpgm
L_late:
    ds_read_b128 v[112:115], v13 offset:0
    ds_read_b128 v[116:119], v13 offset:1024
    ds_read_b128 v[120:123], v13 offset:2048
    ds_read_b128 v[124:127], v13 offset:3072
    ds_read_b128 v[128:131], v13 offset:4096
    ds_read_b128 v[132:135], v13 offset:5120
    ds_read_b128 v[136:139], v13 offset:6144
    ds_read_b128 v[140:143], v13 offset:7168
    buffer_load_dwordx4 v[48:51], v4, s[24:27], s89 offen
    buffer_load_dwordx4 v[56:59], v4, s[24:27], s90 offen
    s_waitcnt lgkmcnt(7)
    v_mfma_f32_16x16x32_bf16 v[160:163], v[112:115], v[184:187], v[64:67]
    ds_read_b128 v[144:147], v13 offset:8192
    v_mov_b32_e64 v24, v8
    v_mfma_f32_16x16x32_bf16 v[164:167], v[112:115], v[232:235], v[64:67]
    ds_read_b128 v[148:151], v13 offset:9216
    v_mov_b32 v25, v9
    s_waitcnt lgkmcnt(8)
    v_mfma_f32_16x16x32_bf16 v[160:163], v[116:119], v[188:191], v[160:163]
    ds_read_b128 v[152:155], v13 offset:10240
    v_mov_b32_e64 v26, 0
    v_mfma_f32_16x16x32_bf16 v[164:167], v[116:119], v[236:239], v[164:167]
    ds_read_b128 v[156:159], v13 offset:11264
    s_waitcnt lgkmcnt(9)
    v_mfma_f32_16x16x32_bf16 v[160:163], v[120:123], v[192:195], v[160:163]
    ds_read_b128 v[68:71], v6 offset:64
    v_mov_b32 v27, 0
    v_mfma_f32_16x16x32_bf16 v[164:167], v[120:123], v[240:243], v[164:167]
    ds_read_b128 v[72:75], v7 offset:0
    v_mov_b32 v28, v8
    s_waitcnt lgkmcnt(10)
    v_mfma_f32_16x16x32_bf16 v[160:163], v[124:127], v[196:199], v[160:163]
    ds_read_b128 v[76:79], v7 offset:64
    v_mov_b32_e64 v29, v9
    v_mfma_f32_16x16x32_bf16 v[164:167], v[124:127], v[244:247], v[164:167]
    s_waitcnt lgkmcnt(7)
    v_mfma_f32_16x16x32_bf16 v[160:163], v[128:131], v[200:203], v[160:163]
    ds_read_b128 v[112:115], v13 offset:12288
    v_mfma_f32_16x16x32_bf16 v[164:167], v[128:131], v[248:251], v[164:167]
    ds_read_b128 v[116:119], v13 offset:13312
    v_mfma_f32_16x16x32_bf16 v[160:163], v[132:135], v[204:207], v[160:163]
    ds_read_b128 v[120:123], v13 offset:14336
    v_mfma_f32_16x16x32_bf16 v[164:167], v[132:135], v[252:255], v[164:167]
    ds_read_b128 v[124:127], v13 offset:15360
    v_mfma_f32_16x16x32_bf16 v[160:163], v[136:139], v[208:211], v[160:163]
    ds_read_b128 v[80:83], v0 offset:0
    v_mfma_f32_16x16x32_bf16 v[164:167], v[136:139], v[88:91], v[164:167]
    ds_read_b128 v[84:87], v0 offset:64
    v_mfma_f32_16x16x32_bf16 v[160:163], v[140:143], v[212:215], v[160:163]
    v_mfma_f32_16x16x32_bf16 v[164:167], v[140:143], v[92:95], v[164:167]
    s_waitcnt lgkmcnt(9)
    v_mfma_f32_16x16x32_bf16 v[160:163], v[144:147], v[216:219], v[160:163]
    ds_read_b128 v[128:131], v13 offset:16384
    v_mfma_f32_16x16x32_bf16 v[164:167], v[144:147], v[96:99], v[164:167]
    ds_read_b128 v[132:135], v13 offset:17408
    v_mfma_f32_16x16x32_bf16 v[160:163], v[148:151], v[220:223], v[160:163]
    ds_read_b128 v[136:139], v13 offset:18432
    v_mfma_f32_16x16x32_bf16 v[164:167], v[148:151], v[100:103], v[164:167]
    ds_read_b128 v[140:143], v13 offset:19456
    v_mfma_f32_16x16x32_bf16 v[160:163], v[152:155], v[224:227], v[160:163]
    v_mfma_f32_16x16x32_bf16 v[164:167], v[152:155], v[104:107], v[164:167]
    v_mfma_f32_16x16x32_bf16 v[160:163], v[156:159], v[228:231], v[160:163]
    v_mfma_f32_16x16x32_bf16 v[164:167], v[156:159], v[108:111], v[164:167]
    s_waitcnt lgkmcnt(6)
    v_mfma_f32_16x16x32_bf16 v[168:171], v[112:115], v[184:187], v[68:71]
    ds_read_b128 v[144:147], v13 offset:20480
    v_mfma_f32_16x16x32_bf16 v[172:175], v[112:115], v[232:235], v[68:71]
    ds_read_b128 v[148:151], v13 offset:21504
    v_mfma_f32_16x16x32_bf16 v[168:171], v[116:119], v[188:191], v[168:171]
    ds_read_b128 v[152:155], v13 offset:22528
    v_mfma_f32_16x16x32_bf16 v[172:175], v[116:119], v[236:239], v[172:175]
    ds_read_b128 v[156:159], v13 offset:23552
    v_mfma_f32_16x16x32_bf16 v[168:171], v[120:123], v[192:195], v[168:171]
    v_mfma_f32_16x16x32_bf16 v[172:175], v[120:123], v[240:243], v[172:175]
    v_mfma_f32_16x16x32_bf16 v[168:171], v[124:127], v[196:199], v[168:171]
    v_mfma_f32_16x16x32_bf16 v[172:175], v[124:127], v[244:247], v[172:175]
    s_waitcnt lgkmcnt(4)
    v_mfma_f32_16x16x32_bf16 v[168:171], v[128:131], v[200:203], v[168:171]
    ds_read_b128 v[112:115], v14 offset:0
    s_waitcnt vmcnt(3)
    v_permlane16_swap_b32 v40, v42
    v_mfma_f32_16x16x32_bf16 v[172:175], v[128:131], v[248:251], v[172:175]
    ds_read_b128 v[116:119], v14 offset:1024
    v_mfma_f32_16x16x32_bf16 v[168:171], v[132:135], v[204:207], v[168:171]
    ds_read_b128 v[120:123], v14 offset:2048
    v_permlane16_swap_b32_e64 v41, v43
    v_mfma_f32_16x16x32_bf16 v[172:175], v[132:135], v[252:255], v[172:175]
    ds_read_b128 v[124:127], v14 offset:3072
    v_mfma_f32_16x16x32_bf16 v[168:171], v[136:139], v[208:211], v[168:171]
    s_waitcnt vmcnt(2)
    v_permlane16_swap_b32 v44, v46
    v_mfma_f32_16x16x32_bf16 v[172:175], v[136:139], v[88:91], v[172:175]
    v_mfma_f32_16x16x32_bf16 v[168:171], v[140:143], v[212:215], v[168:171]
    v_permlane16_swap_b32_e64 v45, v47
    v_mfma_f32_16x16x32_bf16 v[172:175], v[140:143], v[92:95], v[172:175]
    s_waitcnt lgkmcnt(4)
    v_mfma_f32_16x16x32_bf16 v[160:163], v[24:27], v[40:43], v[160:163]
    ds_read_b128 v[128:131], v14 offset:4096
    v_mfma_f32_16x16x32_bf16 v[164:167], v[24:27], v[44:47], v[164:167]
    ds_read_b128 v[132:135], v14 offset:5120
    v_mfma_f32_16x16x32_bf16 v[168:171], v[26:29], v[40:43], v[168:171]
    ds_read_b128 v[136:139], v14 offset:6144
    v_mfma_f32_16x16x32_bf16 v[172:175], v[26:29], v[44:47], v[172:175]
    ds_read_b128 v[140:143], v14 offset:7168
    v_mfma_f32_16x16x32_bf16 v[168:171], v[144:147], v[216:219], v[168:171]
    v_mfma_f32_16x16x32_bf16 v[172:175], v[144:147], v[96:99], v[172:175]
    v_mfma_f32_16x16x32_bf16 v[168:171], v[148:151], v[220:223], v[168:171]
    v_mfma_f32_16x16x32_bf16 v[172:175], v[148:151], v[100:103], v[172:175]
    v_mfma_f32_16x16x32_bf16 v[168:171], v[152:155], v[224:227], v[168:171]
    v_mfma_f32_16x16x32_bf16 v[172:175], v[152:155], v[104:107], v[172:175]
    v_mfma_f32_16x16x32_bf16 v[168:171], v[156:159], v[228:231], v[168:171]
    v_mfma_f32_16x16x32_bf16 v[172:175], v[156:159], v[108:111], v[172:175]
    s_waitcnt lgkmcnt(4)
    v_mfma_f32_16x16x32_bf16 v[176:179], v[112:115], v[184:187], v[72:75]
    ds_read_b128 v[144:147], v14 offset:8192
    v_mfma_f32_16x16x32_bf16 v[176:179], v[116:119], v[188:191], v[176:179]
    ds_read_b128 v[148:151], v14 offset:9216
    v_mfma_f32_16x16x32_bf16 v[176:179], v[120:123], v[192:195], v[176:179]
    ds_read_b128 v[152:155], v14 offset:10240
    v_mfma_f32_16x16x32_bf16 v[176:179], v[124:127], v[196:199], v[176:179]
    ds_read_b128 v[156:159], v14 offset:11264
    s_waitcnt lgkmcnt(4)
    v_mfma_f32_16x16x32_bf16 v[176:179], v[128:131], v[200:203], v[176:179]
    ds_read_b128 v[112:115], v14 offset:12288
    v_cvt_pk_bf16_f32 v16, v160, v161
    v_cvt_pk_bf16_f32 v17, v162, v163
    v_cvt_pk_bf16_f32 v20, v164, v165
    v_cvt_pk_bf16_f32 v21, v166, v167
    v_mfma_f32_16x16x32_bf16 v[176:179], v[132:135], v[204:207], v[176:179]
    ds_read_b128 v[116:119], v14 offset:13312
    v_cvt_pk_bf16_f32 v18, v168, v169
    v_cvt_pk_bf16_f32 v19, v170, v171
    v_cvt_pk_bf16_f32 v22, v172, v173
    v_mfma_f32_16x16x32_bf16 v[176:179], v[136:139], v[208:211], v[176:179]
    ds_read_b128 v[120:123], v14 offset:14336
    v_cvt_pk_bf16_f32 v23, v174, v175
    v_permlane16_swap_b32 v16, v18
    v_permlane16_swap_b32_e64 v17, v19
    buffer_store_dwordx4 v[16:19], v4, s[40:43], s88 offen sc0 sc1
    v_mfma_f32_16x16x32_bf16 v[176:179], v[140:143], v[212:215], v[176:179]
    ds_read_b128 v[124:127], v14 offset:15360
    s_waitcnt lgkmcnt(4)
    v_permlane16_swap_b32 v20, v22
    v_permlane16_swap_b32_e64 v21, v23
    buffer_store_dwordx4 v[20:23], v5, s[40:43], s88 offen sc0 sc1
    v_mfma_f32_16x16x32_bf16 v[176:179], v[144:147], v[216:219], v[176:179]
    ds_read_b128 v[128:131], v14 offset:16384
    v_mfma_f32_16x16x32_bf16 v[176:179], v[148:151], v[220:223], v[176:179]
    ds_read_b128 v[132:135], v14 offset:17408
    v_mfma_f32_16x16x32_bf16 v[176:179], v[152:155], v[224:227], v[176:179]
    ds_read_b128 v[136:139], v14 offset:18432
    v_mfma_f32_16x16x32_bf16 v[176:179], v[156:159], v[228:231], v[176:179]
    ds_read_b128 v[140:143], v14 offset:19456
    s_waitcnt lgkmcnt(4)
    v_mfma_f32_16x16x32_bf16 v[160:163], v[112:115], v[184:187], v[76:79]
    ds_read_b128 v[144:147], v14 offset:20480
    v_mfma_f32_16x16x32_bf16 v[160:163], v[116:119], v[188:191], v[160:163]
    ds_read_b128 v[148:151], v14 offset:21504
    v_mfma_f32_16x16x32_bf16 v[160:163], v[120:123], v[192:195], v[160:163]
    ds_read_b128 v[152:155], v14 offset:22528
    v_mfma_f32_16x16x32_bf16 v[160:163], v[124:127], v[196:199], v[160:163]
    ds_read_b128 v[156:159], v14 offset:23552
    s_waitcnt lgkmcnt(4)
    v_mfma_f32_16x16x32_bf16 v[160:163], v[128:131], v[200:203], v[160:163]
    ds_read_b128 v[112:115], v15 offset:0
    s_waitcnt vmcnt(3)
    v_permlane16_swap_b32 v48, v50
    v_mfma_f32_16x16x32_bf16 v[160:163], v[132:135], v[204:207], v[160:163]
    ds_read_b128 v[116:119], v15 offset:1024
    v_mfma_f32_16x16x32_bf16 v[160:163], v[136:139], v[208:211], v[160:163]
    ds_read_b128 v[120:123], v15 offset:2048
    v_permlane16_swap_b32_e64 v49, v51
    v_mfma_f32_16x16x32_bf16 v[160:163], v[140:143], v[212:215], v[160:163]
    ds_read_b128 v[124:127], v15 offset:3072
    s_waitcnt lgkmcnt(4)
    v_mfma_f32_16x16x32_bf16 v[176:179], v[24:27], v[48:51], v[176:179]
    ds_read_b128 v[128:131], v15 offset:4096
    v_mfma_f32_16x16x32_bf16 v[160:163], v[26:29], v[48:51], v[160:163]
    ds_read_b128 v[132:135], v15 offset:5120
    v_mfma_f32_16x16x32_bf16 v[160:163], v[144:147], v[216:219], v[160:163]
    ds_read_b128 v[136:139], v15 offset:6144
    v_mfma_f32_16x16x32_bf16 v[160:163], v[148:151], v[220:223], v[160:163]
    ds_read_b128 v[140:143], v15 offset:7168
    v_mfma_f32_16x16x32_bf16 v[160:163], v[152:155], v[224:227], v[160:163]
    v_mfma_f32_16x16x32_bf16 v[160:163], v[156:159], v[228:231], v[160:163]
    s_waitcnt lgkmcnt(4)
    v_mfma_f32_16x16x32_bf16 v[168:171], v[112:115], v[184:187], v[80:83]
    ds_read_b128 v[144:147], v15 offset:8192
    v_mfma_f32_16x16x32_bf16 v[168:171], v[116:119], v[188:191], v[168:171]
    ds_read_b128 v[148:151], v15 offset:9216
    v_mfma_f32_16x16x32_bf16 v[168:171], v[120:123], v[192:195], v[168:171]
    ds_read_b128 v[152:155], v15 offset:10240
    v_mfma_f32_16x16x32_bf16 v[168:171], v[124:127], v[196:199], v[168:171]
    ds_read_b128 v[156:159], v15 offset:11264
    s_waitcnt lgkmcnt(4)
    v_mfma_f32_16x16x32_bf16 v[168:171], v[128:131], v[200:203], v[168:171]
    ds_read_b128 v[112:115], v15 offset:12288
    v_cvt_pk_bf16_f32 v16, v176, v177
    v_cvt_pk_bf16_f32 v17, v178, v179
    v_mfma_f32_16x16x32_bf16 v[168:171], v[132:135], v[204:207], v[168:171]
    ds_read_b128 v[116:119], v15 offset:13312
    v_cvt_pk_bf16_f32 v18, v160, v161
    v_cvt_pk_bf16_f32 v19, v162, v163
    v_mfma_f32_16x16x32_bf16 v[168:171], v[136:139], v[208:211], v[168:171]
    ds_read_b128 v[120:123], v15 offset:14336
    v_permlane16_swap_b32 v16, v18
    v_permlane16_swap_b32_e64 v17, v19
    v_mfma_f32_16x16x32_bf16 v[168:171], v[140:143], v[212:215], v[168:171]
    ds_read_b128 v[124:127], v15 offset:15360
    s_waitcnt lgkmcnt(4)
    buffer_store_dwordx4 v[16:19], v4, s[40:43], s89 offen sc0 sc1
    v_mfma_f32_16x16x32_bf16 v[168:171], v[144:147], v[216:219], v[168:171]
    ds_read_b128 v[128:131], v15 offset:16384
    v_mfma_f32_16x16x32_bf16 v[168:171], v[148:151], v[220:223], v[168:171]
    ds_read_b128 v[132:135], v15 offset:17408
    v_mfma_f32_16x16x32_bf16 v[168:171], v[152:155], v[224:227], v[168:171]
    ds_read_b128 v[136:139], v15 offset:18432
    v_mfma_f32_16x16x32_bf16 v[168:171], v[156:159], v[228:231], v[168:171]
    ds_read_b128 v[140:143], v15 offset:19456
    s_waitcnt lgkmcnt(4)
    v_mfma_f32_16x16x32_bf16 v[176:179], v[112:115], v[184:187], v[84:87]
    ds_read_b128 v[144:147], v15 offset:20480
    v_mfma_f32_16x16x32_bf16 v[176:179], v[116:119], v[188:191], v[176:179]
    ds_read_b128 v[148:151], v15 offset:21504
    v_mfma_f32_16x16x32_bf16 v[176:179], v[120:123], v[192:195], v[176:179]
    ds_read_b128 v[152:155], v15 offset:22528
    v_mfma_f32_16x16x32_bf16 v[176:179], v[124:127], v[196:199], v[176:179]
    ds_read_b128 v[156:159], v15 offset:23552
    s_waitcnt lgkmcnt(4)
    v_mfma_f32_16x16x32_bf16 v[176:179], v[128:131], v[200:203], v[176:179]
    s_waitcnt vmcnt(3)
    v_permlane16_swap_b32_e64 v56, v58
    v_mfma_f32_16x16x32_bf16 v[176:179], v[132:135], v[204:207], v[176:179]
    v_mfma_f32_16x16x32_bf16 v[176:179], v[136:139], v[208:211], v[176:179]
    v_permlane16_swap_b32_e64 v57, v59
    v_mfma_f32_16x16x32_bf16 v[176:179], v[140:143], v[212:215], v[176:179]
    s_waitcnt lgkmcnt(0)
    v_mfma_f32_16x16x32_bf16 v[168:171], v[24:27], v[56:59], v[168:171]
    v_mfma_f32_16x16x32_bf16 v[176:179], v[26:29], v[56:59], v[176:179]
    v_mfma_f32_16x16x32_bf16 v[176:179], v[144:147], v[216:219], v[176:179]
    v_mfma_f32_16x16x32_bf16 v[176:179], v[148:151], v[220:223], v[176:179]
    v_mfma_f32_16x16x32_bf16 v[176:179], v[152:155], v[224:227], v[176:179]
    v_mfma_f32_16x16x32_bf16 v[176:179], v[156:159], v[228:231], v[176:179]
    s_nop 2
    v_cvt_pk_bf16_f32 v16, v168, v169
    v_cvt_pk_bf16_f32 v17, v170, v171
    s_nop 2
    v_cvt_pk_bf16_f32 v18, v176, v177
    v_cvt_pk_bf16_f32 v19, v178, v179
    s_nop 0
    v_permlane16_swap_b32 v16, v18
    v_permlane16_swap_b32 v17, v19
    buffer_store_dwordx4 v[16:19], v4, s[40:43], s90 offen sc0 sc1
L_join:
    s_endpgm
L_chores:
    s_setprio 0
    ds_add_u32 v6, v13 offset:8
L_ypoll:
    ds_read_b32 v16, v14 offset:0
    s_waitcnt lgkmcnt(0)
    v_readfirstlane_b32 s74, v16
    s_nop 1
    s_cmp_lt_u32 s74, 8
    s_cbranch_scc1 L_ypoll
    v_bfe_u32 v16, v2, 1, 4
    v_mul_u32_u24 v16, 192, v16
    v_lshl_add_u32 v16, v7, 5, v16
    v_and_b32 v17, 1, v2
    v_lshl_add_u32 v16, v17, 4, v16
    s_mul_i32 s74, s60, 18432
    s_add_u32 s76, s74, 18432
L_w2loop:
    s_add_u32 m0, s74, 73728
    s_add_u32 s75, s74, 0
    buffer_load_dwordx4 v16, s[36:39], s75 offen lds
    s_add_u32 m0, s74, 74752
    s_add_u32 s75, s74, 64
    buffer_load_dwordx4 v16, s[36:39], s75 offen lds
    s_add_u32 m0, s74, 75776
    s_add_u32 s75, s74, 128
    buffer_load_dwordx4 v16, s[36:39], s75 offen lds
    s_add_u32 s74, s74, 3072
    s_cmp_lt_u32 s74, s76
    s_cbranch_scc1 L_w2loop
    s_cmp_lg_u32 s60, 1
    s_cbranch_scc1 L_sk24
    v_lshlrev_b32_e64 v18, 4, v2
    s_mov_b32 m0, 162880
    s_mov_b32 exec_hi, 0xffff
    buffer_load_dwordx4 v18, s[56:59], 0 offen lds
    s_mov_b32 exec_hi, -1
L_sk24:
    s_cmp_lt_u32 s60, 2
    s_cbranch_scc1 L_sk25
L_apoll:
    ds_read_b32 v16, v14 offset:8
    s_waitcnt lgkmcnt(0)
    v_readfirstlane_b32 s74, v16
    s_nop 1
    s_cmp_lt_u32 s74, 4
    s_cbranch_scc1 L_apoll
    v_and_b32_e64 v40, 15, v2
    v_bfe_u32 v41, v2, 4, 1
    v_lshlrev_b32_e64 v41, 9, v41
    v_lshl_add_u32 v41, v7, 7, v41
    v_lshl_add_u32 v42, v40, 3, v41
    v_xor_b32_e64 v43, 64, v42
    v_add_u32 v43, 256, v43
    s_and_b32 s75, s60, 1
    s_mul_i32 s75, s75, 6144
    s_lshr_b32 s76, s60, 1
    s_cmp_eq_u32 s76, 0
    s_cselect_b32 s77, 3, 0
    s_cmp_eq_u32 s76, 1
    s_cselect_b32 s77, -3, s77
    s_add_u32 s76, s84, s77
    s_mul_i32 s76, s76, 12288
    s_add_u32 s76, s76, s75
    v_add_u32 v44, s76, v42
    v_add_u32 v45, s76, v43
    ds_write2st64_b64 v44, v[184:185], v[188:189] offset0:0 offset1:2
    ds_write2st64_b64 v45, v[186:187], v[190:191] offset0:0 offset1:2
    ds_write2st64_b64 v44, v[192:193], v[196:197] offset0:4 offset1:6
    ds_write2st64_b64 v45, v[194:195], v[198:199] offset0:4 offset1:6
    ds_write2st64_b64 v44, v[200:201], v[204:205] offset0:8 offset1:10
    ds_write2st64_b64 v45, v[202:203], v[206:207] offset0:8 offset1:10
    s_add_u32 s76, s85, s77
    s_mul_i32 s76, s76, 12288
    s_add_u32 s76, s76, s75
    v_add_u32 v44, s76, v42
    v_add_u32 v45, s76, v43
    ds_write2st64_b64 v44, v[208:209], v[212:213] offset0:0 offset1:2
    ds_write2st64_b64 v45, v[210:211], v[214:215] offset0:0 offset1:2
    ds_write2st64_b64 v44, v[216:217], v[220:221] offset0:4 offset1:6
    ds_write2st64_b64 v45, v[218:219], v[222:223] offset0:4 offset1:6
    ds_write2st64_b64 v44, v[224:225], v[228:229] offset0:8 offset1:10
    ds_write2st64_b64 v45, v[226:227], v[230:231] offset0:8 offset1:10
    s_add_u32 s76, s86, s77
    s_mul_i32 s76, s76, 12288
    s_add_u32 s76, s76, s75
    v_add_u32 v44, s76, v42
    v_add_u32 v45, s76, v43
    ds_write2st64_b64 v44, v[232:233], v[236:237] offset0:0 offset1:2
    ds_write2st64_b64 v45, v[234:235], v[238:239] offset0:0 offset1:2
    ds_write2st64_b64 v44, v[240:241], v[244:245] offset0:4 offset1:6
    ds_write2st64_b64 v45, v[242:243], v[246:247] offset0:4 offset1:6
    ds_write2st64_b64 v44, v[248:249], v[252:253] offset0:8 offset1:10
    ds_write2st64_b64 v45, v[250:251], v[254:255] offset0:8 offset1:10
    ds_add_u32 v6, v13 offset:20
L_sk25:
    s_cmp_ge_u32 s60, 2
    s_cbranch_scc1 L_sk26
    v_lshlrev_b32_e64 v16, 4, v0
    v_add_u32 v16, 147456, v16
    v_lshrrev_b32 v17, 2, v0
    v_lshlrev_b32 v17, 14, v17
    v_and_b32_e64 v18, 3, v0
    v_lshl_add_u32 v17, v18, 4, v17
    s_lshl_b32 s70, s81, 6
    v_cmp_gt_u32 vcc, 96, v0
    s_nop 1
    s_mov_b64 s[8:9], vcc
L_sk26:
    s_cmp_lg_u32 s60, 2
    s_cbranch_scc1 L_sk27
    s_setprio 2
    s_mov_b32 s98, 0x20000
L_bmr:
    buffer_load_dword v51, v15, s[48:51], 0 offen sc1
    s_waitcnt vmcnt(0)
    v_bcnt_u32_b32 v16, v51, 0
    s_nop 1
    v_add_u32_dpp v16, v16, v16 row_shr:1 row_mask:0xf bank_mask:0xf bound_ctrl:0
    s_nop 1
    v_add_u32_dpp v16, v16, v16 row_shr:2 row_mask:0xf bank_mask:0xf bound_ctrl:0
    s_nop 1
    v_add_u32_dpp v16, v16, v16 row_shr:4 row_mask:0xf bank_mask:0xf bound_ctrl:0
    s_nop 1
    v_add_u32_dpp v16, v16, v16 row_shr:8 row_mask:0xf bank_mask:0xf bound_ctrl:0
    s_nop 1
    v_add_u32_dpp v16, v16, v16 row_bcast:15 row_mask:0xa bank_mask:0xf
    s_nop 1
    v_add_u32_dpp v16, v16, v16 row_bcast:31 row_mask:0xc bank_mask:0xf
    s_nop 0
    v_readlane_b32 s70, v16, 63
    s_nop 1
    s_cmp_eq_u32 s70, 256
    s_cbranch_scc1 L_bmokr
    s_sub_u32 s98, s98, 1
    s_cmp_lt_i32 s98, 0
    s_cbranch_scc1 L_bmokr
    s_sleep 8
    s_branch L_bmr
L_bmokr:
    s_mov_b32 s98, 0x20000
    v_cmp_ne_u32 s[96:97], 0, v51
    s_lshl_b32 s70, s80, 3
    s_add_u32 s71, s70, 0
    v_readlane_b32 s88, v51, s71
    s_add_u32 s71, s70, 1
    v_readlane_b32 s89, v51, s71
    s_add_u32 s71, s70, 2
    v_readlane_b32 s90, v51, s71
    s_add_u32 s71, s70, 3
    v_readlane_b32 s91, v51, s71
    s_add_u32 s71, s70, 4
    v_readlane_b32 s92, v51, s71
    s_add_u32 s71, s70, 5
    v_readlane_b32 s93, v51, s71
    s_add_u32 s71, s70, 6
    v_readlane_b32 s94, v51, s71
    s_add_u32 s71, s70, 7
    v_readlane_b32 s95, v51, s71
    s_mov_b32 s83, 0
    s_mov_b32 s82, 0
    s_lshr_b32 s72, s81, 5
    s_lshl_b32 s73, 1, s81
    s_sub_u32 s73, s73, 1
    s_bcnt1_i32_b32 s71, s88
    s_add_u32 s83, s83, s71
    s_cmp_gt_u32 s72, 0
    s_cselect_b32 s74, -1, 0
    s_cmp_eq_u32 s72, 0
    s_cselect_b32 s74, s73, s74
    s_and_b32 s74, s74, s88
    s_bcnt1_i32_b32 s71, s74
    s_add_u32 s82, s82, s71
    s_bcnt1_i32_b32 s71, s89
    s_add_u32 s83, s83, s71
    s_cmp_gt_u32 s72, 1
    s_cselect_b32 s74, -1, 0
    s_cmp_eq_u32 s72, 1
    s_cselect_b32 s74, s73, s74
    s_and_b32 s74, s74, s89
    s_bcnt1_i32_b32 s71, s74
    s_add_u32 s82, s82, s71
    s_bcnt1_i32_b32 s71, s90
    s_add_u32 s83, s83, s71
    s_cmp_gt_u32 s72, 2
    s_cselect_b32 s74, -1, 0
    s_cmp_eq_u32 s72, 2
    s_cselect_b32 s74, s73, s74
    s_and_b32 s74, s74, s90
    s_bcnt1_i32_b32 s71, s74
    s_add_u32 s82, s82, s71
    s_bcnt1_i32_b32 s71, s91
    s_add_u32 s83, s83, s71
    s_cmp_gt_u32 s72, 3
    s_cselect_b32 s74, -1, 0
    s_cmp_eq_u32 s72, 3
    s_cselect_b32 s74, s73, s74
    s_and_b32 s74, s74, s91
    s_bcnt1_i32_b32 s71, s74
    s_add_u32 s82, s82, s71
    s_bcnt1_i32_b32 s71, s92
    s_add_u32 s83, s83, s71
    s_cmp_gt_u32 s72, 4
    s_cselect_b32 s74, -1, 0
    s_cmp_eq_u32 s72, 4
    s_cselect_b32 s74, s73, s74
    s_and_b32 s74, s74, s92
    s_bcnt1_i32_b32 s71, s74
    s_add_u32 s82, s82, s71
    s_bcnt1_i32_b32 s71, s93
    s_add_u32 s83, s83, s71
    s_cmp_gt_u32 s72, 5
    s_cselect_b32 s74, -1, 0
    s_cmp_eq_u32 s72, 5
    s_cselect_b32 s74, s73, s74
    s_and_b32 s74, s74, s93
    s_bcnt1_i32_b32 s71, s74
    s_add_u32 s82, s82, s71
    s_bcnt1_i32_b32 s71, s94
    s_add_u32 s83, s83, s71
    s_cmp_gt_u32 s72, 6
    s_cselect_b32 s74, -1, 0
    s_cmp_eq_u32 s72, 6
    s_cselect_b32 s74, s73, s74
    s_and_b32 s74, s74, s94
    s_bcnt1_i32_b32 s71, s74
    s_add_u32 s82, s82, s71
    s_bcnt1_i32_b32 s71, s95
    s_add_u32 s83, s83, s71
    s_cmp_gt_u32 s72, 7
    s_cselect_b32 s74, -1, 0
    s_cmp_eq_u32 s72, 7
    s_cselect_b32 s74, s73, s74
    s_and_b32 s74, s74, s95
    s_bcnt1_i32_b32 s71, s74
    s_add_u32 s82, s82, s71
    s_max_u32 s83, s83, 1
    v_and_b32 v17, 15, v2
    v_lshrrev_b32 v19, 4, v2
    v_lshlrev_b32_e64 v19, 4, v19
    v_lshl_add_u32 v16, v17, 6, v19
    v_and_b32 v18, 7, v2
    v_lshlrev_b32 v20, 3, v18
    v_lshrrev_b64 v[20:21], v20, s[96:97]
    v_and_b32 v20, 0xff, v20
    v_and_b32_e64 v21, 8, v2
    v_cmp_ne_u32 s[8:9], 0, v20
    v_cmp_eq_u32 vcc, 0, v21
    v_lshl_add_u32 v18, v18, 6, v19
    s_nop 0
    s_and_b64 s[8:9], s[8:9], vcc
    s_lshl_b32 s70, s80, 3
    s_lshr_b64 s[96:97], s[96:97], s70
    s_and_b32 s96, s96, 0xff
L_sk27:
    s_cmp_lg_u32 s60, 3
    s_cbranch_scc1 L_sk28
    v_mul_u32_u24 v40, 12, v2
    buffer_load_dwordx3 v[48:50], v40, s[52:55], 0 offen
    s_setprio 2
    s_mov_b32 s98, 0x20000
L_bmc:
    buffer_load_dword v51, v15, s[48:51], 0 offen sc1
    s_waitcnt vmcnt(0)
    v_bcnt_u32_b32 v16, v51, 0
    s_nop 1
    v_add_u32_dpp v16, v16, v16 row_shr:1 row_mask:0xf bank_mask:0xf bound_ctrl:0
    s_nop 1
    v_add_u32_dpp v16, v16, v16 row_shr:2 row_mask:0xf bank_mask:0xf bound_ctrl:0
    s_nop 1
    v_add_u32_dpp v16, v16, v16 row_shr:4 row_mask:0xf bank_mask:0xf bound_ctrl:0
    s_nop 1
    v_add_u32_dpp v16, v16, v16 row_shr:8 row_mask:0xf bank_mask:0xf bound_ctrl:0
    s_nop 1
    v_add_u32_dpp v16, v16, v16 row_bcast:15 row_mask:0xa bank_mask:0xf
    s_nop 1
    v_add_u32_dpp v16, v16, v16 row_bcast:31 row_mask:0xc bank_mask:0xf
    s_nop 0
    v_readlane_b32 s70, v16, 63
    s_nop 1
    s_cmp_eq_u32 s70, 256
    s_cbranch_scc1 L_bmokc
    s_sub_u32 s98, s98, 1
    s_cmp_lt_i32 s98, 0
    s_cbranch_scc1 L_bmokc
    s_sleep 8
    s_branch L_bmc
L_bmokc:
    s_mov_b32 s98, 0x20000
L_sk28:
    s_waitcnt vmcnt(0)
    s_mul_i32 s75, s63, 18432
    s_mul_i32 s76, s64, 1536
    s_add_u32 s75, s75, s76
    s_add_u32 s75, s75, 73728
    v_lshl_add_u32 v40, v2, 3, s75
    ds_read_b64_tr_b16 v[52:53], v40 offset:0
    ds_read_b64_tr_b16 v[54:55], v40 offset:3072
    ds_read_b64_tr_b16 v[56:57], v40 offset:512
    ds_read_b64_tr_b16 v[58:59], v40 offset:3584
    ds_read_b64_tr_b16 v[60:61], v40 offset:1024
    ds_read_b64_tr_b16 v[62:63], v40 offset:4096
    ds_read_b64_tr_b16 v[64:65], v40 offset:6144
    ds_read_b64_tr_b16 v[66:67], v40 offset:9216
    ds_read_b64_tr_b16 v[68:69], v40 offset:6656
    ds_read_b64_tr_b16 v[70:71], v40 offset:9728
    ds_read_b64_tr_b16 v[72:73], v40 offset:7168
    ds_read_b64_tr_b16 v[74:75], v40 offset:10240
    ds_read_b64_tr_b16 v[76:77], v40 offset:12288
    ds_read_b64_tr_b16 v[78:79], v40 offset:15360
    ds_read_b64_tr_b16 v[80:81], v40 offset:12800
    ds_read_b64_tr_b16 v[82:83], v40 offset:15872
    ds_read_b64_tr_b16 v[84:85], v40 offset:13312
    ds_read_b64_tr_b16 v[86:87], v40 offset:16384
    ds_add_u32 v6, v13 offset:16
    s_branch L_sk23
L_end:
    s_endpgm
.section .rodata,"a"
.p2align 6
.amdhsa_kernel standalone__modern_conv_block_slak__vision_kernel
  .amdhsa_next_free_vgpr 256
  .amdhsa_next_free_sgpr 102
  .amdhsa_accum_offset 256
  .amdhsa_group_segment_fixed_size 0
  .amdhsa_kernarg_size 72
  .amdhsa_user_sgpr_count 2
  .amdhsa_user_sgpr_kernarg_segment_ptr 1
  .amdhsa_system_sgpr_workgroup_id_x 1
.end_amdhsa_kernel
```
